```python
import torch

def _softmax(x, axis=-1):
    return torch.softmax(x, dim=axis)
def _gelu(x):
    return torch.nn.functional.gelu(x, approximate="tanh")
def _silu(x):
    return torch.nn.functional.silu(x)
def _sigmoid(x):
    return torch.sigmoid(x)
def _layernorm(x, axis=-1, eps=1e-5):
    m = x.mean(dim=axis, keepdim=True)
    v = x.var(dim=axis, keepdim=True, unbiased=False)
    return (x - m) / torch.sqrt(v + eps)
def _scatter_add(tgt, idx, src, axis=0):
    return tgt.clone().index_add_(axis, idx, src)
def _segment_sum(src, seg, n):
    out = torch.zeros((n,) + src.shape[1:], dtype=src.dtype)
    return out.index_add_(0, seg, src)
def _pad(x, pw):
    flat = tuple(v for pair in reversed(pw) for v in pair)
    return torch.nn.functional.pad(x, flat)

kernel_name = 'gated_mix__linear_kernel_hedgehog__ssm_conv_s4d__prompt'

def setup_inputs():

    _w = (lambda a: (lambda t: t.to(torch.bfloat16) if t.is_floating_point() else t)(torch.as_tensor(a)))
    def _A_setup():
        B, S, D, H = 1, 2048, 512, 32
        Dh = D // H
        return {
            "x": _w((lambda *s: torch.randn(*s, dtype=torch.bfloat16) * 0.05)(B, S, D)),
            "wqkv": _w((lambda *s: torch.randn(*s, dtype=torch.bfloat16) * 0.8)(D, 3 * D)),
            "w_phi": _w((lambda *s: torch.randn(*s, dtype=torch.bfloat16) * 0.8)(H, Dh, Dh) * (Dh ** -0.5)),
            "wo": _w((lambda *s: torch.randn(*s, dtype=torch.bfloat16) * 0.05)(D, D)),
        }
    _A_in = _A_setup()

    def _B_setup():
        Bsz, L, D, N = 1, 2048, 512, 128
        return {
            "u": _w((lambda *s: torch.randn(*s, dtype=torch.bfloat16) * 0.05)(Bsz, L, D)),
            "log_A_real": _w((lambda *s: torch.randn(*s, dtype=torch.bfloat16) * 6.4)(D, N) * 0.5),
            "A_imag": _w((lambda *s: torch.randn(*s, dtype=torch.bfloat16) * 0.05)(D, N) * 3.14),
            "C_real": _w((lambda *s: torch.randn(*s, dtype=torch.bfloat16) * 0.2)(D, N) / N ** 0.5),
            "C_imag": _w((lambda *s: torch.randn(*s, dtype=torch.bfloat16) * 0.2)(D, N) / N ** 0.5),
            "log_dt": _w((lambda *s: torch.randn(*s, dtype=torch.bfloat16) * 0.05)(D) * 0.5 - 4.0),
            "D_skip": _w((lambda *s: torch.randn(*s, dtype=torch.bfloat16) * 0.05)(D)),
        }
    _B_in = _B_setup()

    return {
        "A_x": _A_in["x"],
        "A_wqkv": _A_in["wqkv"],
        "A_w_phi": _A_in["w_phi"],
        "A_wo": _A_in["wo"],
        "B_u": _B_in["u"],
        "B_log_A_real": _B_in["log_A_real"],
        "B_A_imag": _B_in["A_imag"],
        "B_C_real": _B_in["C_real"],
        "B_C_imag": _B_in["C_imag"],
        "B_log_dt": _B_in["log_dt"],
        "B_D_skip": _B_in["D_skip"],
        "gate_w": _w((lambda *s: torch.randn(*s, dtype=torch.bfloat16) * 0.05)(512) * 16.0),
    }

def reference(A_x, A_wqkv, A_w_phi, A_wo, B_u, B_log_A_real, B_A_imag, B_C_real, B_C_imag, B_log_dt, B_D_skip, gate_w):
    def _A_ref(x, wqkv, w_phi, wo):
        B, S, D = x.shape
        H = 32; Dh = D // H
        qkv = (lambda x, *d: x.permute(*d))((x @ wqkv).reshape(B, S, 3, H, Dh), 2, 0, 3, 1, 4)
        q, k, v = qkv[0], qkv[1], qkv[2]
        pq = torch.einsum("bhsd,hdf->bhsf", q, w_phi)
        pk = torch.einsum("bhsd,hdf->bhsf", k, w_phi)
        phi_q = torch.concatenate([_softmax(pq, axis=-1), _softmax(-pq, axis=-1)], axis=-1)
        phi_k = torch.concatenate([_softmax(pk, axis=-1), _softmax(-pk, axis=-1)], axis=-1)
        kv = torch.einsum("bhsf,bhsd->bhfd", phi_k, v)
        z  = torch.einsum("bhsf->bhf", phi_k)
        num = torch.einsum("bhqf,bhfd->bhqd", phi_q, kv)
        den = torch.einsum("bhqf,bhf->bhq", phi_q, z)[..., None] + 1e-6
        o = num / den
        return (lambda x, *d: x.permute(*d))(o, 0, 2, 1, 3).reshape(B, S, D) @ wo

    def _B_ref(u, log_A_real, A_imag, C_real, C_imag, log_dt, D_skip):
        L = u.shape[1]
        dt = torch.exp(log_dt)
        A = -torch.exp(log_A_real) + 1j * A_imag
        C = (C_real + 1j * C_imag) * dt[:, None]
        pos = (lambda x, dt: x.to(dt))(torch.arange(L), log_dt.dtype)
        P = torch.exp((A * dt[:, None])[:, :, None] * pos[None, None, :])
        K = 2.0 * torch.einsum("dn,dnl->dl", C, P).real
        L2 = 2 * L
        u_t = (lambda x, *d: x.permute(*d))(u, 0, 2, 1)
        Kf = (lambda x, *a, **k: torch.fft.rfft(x.float(), *a, **k))(K, L2)
        Uf = (lambda x, *a, **k: torch.fft.rfft(x.float(), *a, **k))(u_t, L2)
        y = (lambda x, *a, **k: torch.fft.irfft(x, *a, **k).to(torch.bfloat16))(Uf * Kf[None, :, :], L2)[:, :, :L]
        y = (lambda x, *d: x.permute(*d))(y, 0, 2, 1)
        return y + u * D_skip[None, None, :]

    x = A_x
    g = _sigmoid((x * gate_w).sum(-1, keepdims=True))
    a = _A_ref(x, A_wqkv, A_w_phi, A_wo)
    b = _B_ref(x, B_log_A_real, B_A_imag, B_C_real, B_C_imag, B_log_dt, B_D_skip)
    return g * a + (1 - g) * b
```

```asm
; @launch kernel=mix_kernel grid=(256,1,1) block=(512,1,1) lds=163840
; @launch kernel=fin_kernel grid=(256,1,1) block=(256,1,1) lds=110592
.amdgcn_target "amdgcn-amd-amdhsa--gfx950"
.text
.globl mix_kernel
.p2align 8
.type mix_kernel,@function
mix_kernel:
  s_cmp_ge_u32 s2, 256
  s_cbranch_scc1 L_mix_kernel_end
  s_load_dwordx16 s[4:19], s[0:1], 0
  s_load_dwordx8 s[20:27], s[0:1], 64
  s_load_dwordx4 s[28:31], s[0:1], 96
  s_load_dwordx2 s[32:33], s[0:1], 112
  v_lshrrev_b32 v1, 6, v0
  s_and_b32 s35, s2, 7
  v_readfirstlane_b32 s34, v1
  s_lshr_b32 s37, s2, 3
  s_lshr_b32 s36, s37, 1
  s_bitcmp1_b32 s37, 0
  s_cbranch_scc1 L_mix_kernel_B
L_mix_kernel_A:
  s_and_b32 s64, s35, 3
  s_lshl_b32 s64, s64, 2
  s_and_b32 s65, s36, 3
  s_add_u32 s37, s64, s65
  s_lshr_b32 s64, s35, 2
  s_lshl_b32 s64, s64, 2
  s_lshr_b32 s65, s36, 2
  s_add_u32 s67, s64, s65
  s_and_b32 s78, s34, 3
  s_lshr_b32 s79, s34, 2
  s_lshl_b32 s64, s67, 1
  s_add_u32 s38, s64, s79
  v_and_b32 v1, 63, v0
  v_lshrrev_b32 v7, 4, v1
  v_xor_b32 v7, v7, v1
  v_and_b32 v7, 7, v7
  v_lshlrev_b32 v7, 4, v7
  v_lshrrev_b32 v8, 3, v1
  v_lshl_add_u32 v2, v8, 10, v7
  v_xor_b32 v3, 64, v2
  v_add_u32 v3, 8192, v3
  v_add_u32 v9, 0, v1
  v_mul_u32_u24 v7, 171, v9
  v_lshrrev_b32 v7, 12, v7
  v_mul_u32_u24 v8, 24, v7
  v_sub_u32 v8, v9, v8
  v_bfe_u32 v9, v7, 1, 1
  v_lshlrev_b32 v9, 2, v9
  v_xor_b32 v8, v8, v9
  v_mul_u32_u24 v4, 3072, v7
  v_lshrrev_b32 v9, 3, v8
  v_lshl_add_u32 v4, v9, 10, v4
  v_and_b32 v8, 7, v8
  v_lshl_add_u32 v4, v8, 4, v4
  v_add_u32 v9, 64, v1
  v_mul_u32_u24 v7, 171, v9
  v_lshrrev_b32 v7, 12, v7
  v_mul_u32_u24 v8, 24, v7
  v_sub_u32 v8, v9, v8
  v_bfe_u32 v9, v7, 1, 1
  v_lshlrev_b32 v9, 2, v9
  v_xor_b32 v8, v8, v9
  v_mul_u32_u24 v5, 3072, v7
  v_lshrrev_b32 v9, 3, v8
  v_lshl_add_u32 v5, v9, 10, v5
  v_and_b32 v8, 7, v8
  v_lshl_add_u32 v5, v8, 4, v5
  v_add_u32 v9, 128, v1
  v_mul_u32_u24 v7, 171, v9
  v_lshrrev_b32 v7, 12, v7
  v_mul_u32_u24 v8, 24, v7
  v_sub_u32 v8, v9, v8
  v_bfe_u32 v9, v7, 1, 1
  v_lshlrev_b32 v9, 2, v9
  v_xor_b32 v8, v8, v9
  v_mul_u32_u24 v6, 3072, v7
  v_lshrrev_b32 v9, 3, v8
  v_lshl_add_u32 v6, v9, 10, v6
  v_and_b32 v8, 7, v8
  v_lshl_add_u32 v6, v8, 4, v6
  s_lshl_b32 s66, s37, 17
  s_lshl_b32 s64, s34, 14
  s_add_u32 s66, s66, s64
  s_mul_i32 s68, s34, 24576
  s_lshl_b32 s64, s67, 7
  s_add_u32 s68, s68, s64
  s_lshl_b32 s69, s34, 11
  s_add_u32 s69, s69, 75776
  s_mul_i32 s70, s34, 3072
  s_add_u32 s70, s70, 2048
  s_lshr_b32 s64, s36, 2
  s_and_b32 s65, s36, 3
  s_add_u32 s64, s64, s65
  s_and_b32 s64, s64, 3
  s_lshl_b32 s64, s64, 1
  s_lshl_b32 s71, s64, 7
  s_mul_i32 s72, s64, 196608
  s_waitcnt lgkmcnt(0)
  s_mov_b32 s40, s4
  s_and_b32 s41, s5, 0xffff
  s_mov_b32 s42, 2097152
  s_mov_b32 s43, 0x20000
  s_mov_b32 s44, s6
  s_and_b32 s45, s7, 0xffff
  s_mov_b32 s46, 1572864
  s_mov_b32 s47, 0x20000
  s_add_u32 s73, s66, s71
  s_add_u32 m0, s69, 0
  s_nop 0
  buffer_load_dwordx4 v2, s[40:43], s73 offen lds
  s_add_u32 m0, s69, 1024
  s_nop 0
  buffer_load_dwordx4 v3, s[40:43], s73 offen lds
  s_add_u32 s85, s68, s72
  s_add_u32 m0, s70, 0
  s_nop 0
  buffer_load_dwordx4 v4, s[44:47], s85 offen lds
  s_add_u32 m0, s70, 1024
  s_nop 0
  buffer_load_dwordx4 v5, s[44:47], s85 offen lds
  s_add_u32 m0, s70, 2048
  s_nop 0
  buffer_load_dwordx4 v6, s[44:47], s85 offen lds
  s_add_u32 s71, s71, 128
  s_and_b32 s71, s71, 0x3ff
  s_add_u32 s73, s66, s71
  s_add_u32 m0, s69, 16384
  s_nop 0
  buffer_load_dwordx4 v2, s[40:43], s73 offen lds
  s_add_u32 m0, s69, 17408
  s_nop 0
  buffer_load_dwordx4 v3, s[40:43], s73 offen lds
  s_add_u32 s72, s72, 196608
  s_cmp_eq_u32 s72, 1572864
  s_cselect_b32 s72, 0, s72
  s_add_u32 s85, s68, s72
  s_add_u32 m0, s70, 24576
  s_nop 0
  buffer_load_dwordx4 v4, s[44:47], s85 offen lds
  s_add_u32 m0, s70, 25600
  s_nop 0
  buffer_load_dwordx4 v5, s[44:47], s85 offen lds
  s_add_u32 m0, s70, 26624
  s_nop 0
  buffer_load_dwordx4 v6, s[44:47], s85 offen lds
  v_and_b32 v7, 31, v1
  v_lshlrev_b32 v29, 5, v7
  v_lshrrev_b32 v7, 5, v1
  v_lshl_add_u32 v28, v7, 10, v29
  s_lshl_b32 s64, s37, 7
  s_and_b32 s65, s67, 7
  s_lshl_b32 s65, s65, 4
  s_add_u32 s64, s64, s65
  s_lshl_b32 s65, s34, 1
  s_add_u32 s82, s64, s65
  global_load_dwordx4 v[20:23], v29, s[26:27]
  global_load_dwordx4 v[24:27], v29, s[26:27] offset:16
  s_mov_b32 s56, s30
  s_and_b32 s57, s31, 0xffff
  s_mov_b32 s58, 256
  s_mov_b32 s59, 0x20000
  s_mov_b32 s60, s8
  s_and_b32 s61, s9, 0xffff
  s_mov_b32 s62, 16384
  s_mov_b32 s63, 0x20000
  s_mov_b32 s48, s32
  s_and_b32 s49, s33, 0xffff
  s_mov_b32 s50, 8388608
  s_mov_b32 s51, 0x20000
  v_mov_b32 v30, 0
  v_lshlrev_b32 v31, 4, v1
  s_lshl_b32 s39, s38, 10
  s_lshl_b32 s64, s79, 10
  s_add_u32 m0, s64, 0
  s_lshl_b32 s64, s38, 2
  buffer_load_dwordx4 v31, s[60:63], s39 offen lds
  s_mov_b32 s74, 0x3fb8aa3b
  s_mov_b32 s75, 0x3fb8aa3b
  s_mov_b32 s76, 0x0000ffff
  s_mov_b32 s77, 0x0000ffff
  s_or_b32 s64, s37, s78
  s_cmp_eq_u32 s64, 0
  s_cselect_b32 s84, 1, 0
  v_and_b32 v33, 31, v1
  v_lshrrev_b32 v34, 5, v1
  v_lshrrev_b32 v7, 1, v33
  v_and_b32 v7, 7, v7
  v_xor_b32 v7, v7, v34
  v_lshlrev_b32 v7, 4, v7
  v_lshl_add_u32 v36, v33, 7, v7
  s_lshl_b32 s64, s78, 12
  s_add_u32 s64, s64, 75776
  v_add_u32 v36, s64, v36
  v_xor_b32 v37, 32, v36
  v_xor_b32 v38, 64, v36
  v_xor_b32 v39, 96, v36
  v_bfe_u32 v7, v1, 2, 2
  v_lshl_add_u32 v8, v34, 3, v7
  v_mul_u32_u24 v40, 384, v8
  v_bfe_u32 v8, v1, 4, 1
  v_lshlrev_b32 v8, 5, v8
  v_and_b32 v9, 3, v1
  v_lshl_add_u32 v8, v9, 3, v8
  s_lshl_b32 s64, s79, 6
  v_add_u32 v8, s64, v8
  v_lshrrev_b32 v7, 1, v7
  v_lshlrev_b32 v7, 6, v7
  v_xor_b32 v8, v8, v7
  v_add_u32 v40, v40, v8
  v_add_u32 v40, 2048, v40
  v_add_u32 v41, 49152, v40
  v_lshlrev_b32 v7, 4, v34
  v_sub_u32 v7, v33, v7
  v_and_b32 v8, 1, v7
  v_lshlrev_b32 v8, 4, v8
  v_mov_b32 v9, 0x3f80
  v_lshlrev_b32 v8, v8, v9
  v_lshrrev_b32 v7, 1, v7
  v_cmp_eq_u32 vcc, 0, v7
  s_nop 1
  v_cndmask_b32 v44, 0, v8, vcc
  v_cmp_eq_u32 vcc, 1, v7
  s_nop 1
  v_cndmask_b32 v45, 0, v8, vcc
  v_cmp_eq_u32 vcc, 2, v7
  s_nop 1
  v_cndmask_b32 v46, 0, v8, vcc
  v_cmp_eq_u32 vcc, 3, v7
  s_nop 1
  v_cndmask_b32 v47, 0, v8, vcc
  v_lshlrev_b32 v7, 4, v34
  v_sub_u32 v7, v33, v7
  v_subrev_u32 v7, 8, v7
  v_and_b32 v8, 1, v7
  v_lshlrev_b32 v8, 4, v8
  v_mov_b32 v9, 0x3f80
  v_lshlrev_b32 v8, v8, v9
  v_lshrrev_b32 v7, 1, v7
  v_cmp_eq_u32 vcc, 0, v7
  s_nop 1
  v_cndmask_b32 v48, 0, v8, vcc
  v_cmp_eq_u32 vcc, 1, v7
  s_nop 1
  v_cndmask_b32 v49, 0, v8, vcc
  v_cmp_eq_u32 vcc, 2, v7
  s_nop 1
  v_cndmask_b32 v50, 0, v8, vcc
  v_cmp_eq_u32 vcc, 3, v7
  s_nop 1
  v_cndmask_b32 v51, 0, v8, vcc
  v_mov_b32 v52, 0
  v_mov_b32 v53, 0
  v_mov_b32 v54, 0
  v_mov_b32 v55, 0
  v_bfe_u32 v7, v1, 2, 2
  v_lshl_add_u32 v7, v34, 2, v7
  v_lshlrev_b32 v164, 5, v7
  v_bfe_u32 v8, v1, 4, 1
  v_lshl_add_u32 v164, v8, 4, v164
  v_bfe_u32 v8, v1, 1, 1
  v_lshl_add_u32 v164, v8, 3, v164
  s_lshl_b32 s64, s79, 10
  v_add_u32 v164, s64, v164
  v_bfe_u32 v165, v1, 2, 1
  v_mul_u32_u24 v165, 0x8000, v165
  v_lshl_or_b32 v165, v165, 16, v165
  v_mov_b32 v166, 0x3f803f80
  v_and_b32 v7, 15, v33
  v_lshlrev_b32 v7, 4, v7
  v_lshl_add_u32 v7, v34, 9, v7
  v_lshlrev_b32 v8, 5, v34
  v_add_u32 v8, 2048, v8
  s_mul_i32 s64, s78, 4352
  s_mul_i32 s65, s79, 49152
  s_add_u32 s64, s64, s65
  s_add_u32 s64, s64, 2048
  v_cndmask_b32 v168, v8, v7, s[76:77]
  v_cndmask_b32 v169, v7, v8, s[76:77]
  v_add_u32 v168, s64, v168
  v_add_u32 v169, s64, v169
  v_mov_b32 v7, 256
  v_mov_b32 v8, 16
  v_cndmask_b32 v170, v8, v7, s[76:77]
  v_cndmask_b32 v171, v7, v8, s[76:77]
  v_mad_u32_u24 v172, v170, 0, v168
  v_mad_u32_u24 v173, v170, 4, v168
  v_mad_u32_u24 v174, v170, 1, v168
  v_mad_u32_u24 v175, v170, 5, v168
  v_mad_u32_u24 v176, v171, 0, v169
  v_mad_u32_u24 v177, v171, 4, v169
  v_mad_u32_u24 v178, v171, 1, v169
  v_mad_u32_u24 v179, v171, 5, v169
  s_mul_i32 s64, s38, 4352
  s_add_u32 s64, s64, 6815744
  s_add_u32 s52, s32, s64
  s_addc_u32 s53, s33, 0
  s_and_b32 s53, s53, 0xffff
  s_mov_b32 s54, 4352
  s_mov_b32 s55, 0x20000
  s_lshl_b32 s83, s38, 2
  s_add_u32 s83, s83, 64
  s_lshl_b32 s81, s37, 2
  s_add_u32 s81, s81, s78
  s_lshl_b32 s81, s81, 16
  s_lshl_b32 s64, s38, 12
  s_add_u32 s81, s81, s64
  v_and_b32 v168, 255, v0
  v_lshlrev_b32 v168, 2, v168
  s_mul_i32 s65, s79, 49152
  v_add_u32 v169, s65, v168
  s_waitcnt vmcnt(8)
  s_barrier
  ds_read_b128 v[104:107], v36 offset:0
  ds_read_b64_tr_b16 v[108:109], v40 offset:0
  ds_read_b64_tr_b16 v[110:111], v40 offset:1536
  ds_read_b64_tr_b16 v[112:113], v40 offset:128
  ds_read_b64_tr_b16 v[114:115], v40 offset:1664
  ds_read_b64_tr_b16 v[116:117], v40 offset:256
  ds_read_b64_tr_b16 v[118:119], v40 offset:1792
  ds_read_b128 v[120:123], v37 offset:0
  ds_read_b64_tr_b16 v[124:125], v40 offset:6144
  ds_read_b64_tr_b16 v[126:127], v40 offset:7680
  ds_read_b64_tr_b16 v[128:129], v40 offset:6272
  ds_read_b64_tr_b16 v[130:131], v40 offset:7808
  ds_read_b64_tr_b16 v[132:133], v40 offset:6400
  ds_read_b64_tr_b16 v[134:135], v40 offset:7936
  s_waitcnt lgkmcnt(11)
  v_mfma_f32_32x32x16_bf16 v[56:71], v[108:111], v[104:107], 0
  ds_read_b128 v[136:139], v38 offset:0
  ds_read_b64_tr_b16 v[140:141], v40 offset:12288
  s_add_u32 s72, s72, 196608
  s_cmp_eq_u32 s72, 1572864
  s_cselect_b32 s72, 0, s72
  s_add_u32 s85, s68, s72
  s_add_u32 m0, s70, 49152
  s_nop 0
  buffer_load_dwordx4 v4, s[44:47], s85 offen lds
  s_waitcnt lgkmcnt(11)
  v_mfma_f32_32x32x16_bf16 v[72:87], v[112:115], v[104:107], 0
  ds_read_b64_tr_b16 v[142:143], v40 offset:13824
  ds_read_b64_tr_b16 v[144:145], v40 offset:12416
  ds_read_b64_tr_b16 v[146:147], v40 offset:13952
  s_add_u32 m0, s70, 50176
  s_nop 0
  buffer_load_dwordx4 v5, s[44:47], s85 offen lds
  s_waitcnt lgkmcnt(12)
  v_mfma_f32_32x32x16_bf16 v[88:103], v[104:107], v[116:119], 0
  ds_read_b64_tr_b16 v[148:149], v40 offset:12544
  ds_read_b64_tr_b16 v[150:151], v40 offset:14080
  s_cmp_eq_u32 s84, 1
  s_cbranch_scc1 L_mix_kernel_A_ev4
L_mix_kernel_A_ev4ret:
  s_waitcnt lgkmcnt(11)
  v_mfma_f32_32x32x16_bf16 v[56:71], v[124:127], v[120:123], v[56:71]
  ds_read_b128 v[104:107], v39 offset:0
  ds_read_b64_tr_b16 v[108:109], v40 offset:18432
  s_add_u32 m0, s70, 51200
  s_nop 0
  buffer_load_dwordx4 v6, s[44:47], s85 offen lds
  s_waitcnt lgkmcnt(11)
  v_mfma_f32_32x32x16_bf16 v[72:87], v[128:131], v[120:123], v[72:87]
  ds_read_b64_tr_b16 v[110:111], v40 offset:19968
  ds_read_b64_tr_b16 v[112:113], v40 offset:18560
  ds_read_b64_tr_b16 v[114:115], v40 offset:20096
  s_add_u32 s71, s71, 128
  s_and_b32 s71, s71, 0x3ff
  s_add_u32 s73, s66, s71
  s_add_u32 m0, s69, 32768
  s_nop 0
  buffer_load_dwordx4 v2, s[40:43], s73 offen lds
  s_waitcnt lgkmcnt(12)
  v_mfma_f32_32x32x16_bf16 v[88:103], v[120:123], v[132:135], v[88:103]
  ds_read_b64_tr_b16 v[116:117], v40 offset:18688
  ds_read_b64_tr_b16 v[118:119], v40 offset:20224
  s_waitcnt vmcnt(7)
  s_waitcnt lgkmcnt(0)
  s_barrier
  v_mfma_f32_32x32x16_bf16 v[56:71], v[140:143], v[136:139], v[56:71]
  ds_read_b128 v[120:123], v36 offset:16384
  ds_read_b64_tr_b16 v[124:125], v40 offset:24576
  s_add_u32 m0, s69, 33792
  s_nop 0
  buffer_load_dwordx4 v3, s[40:43], s73 offen lds
  v_mfma_f32_32x32x16_bf16 v[72:87], v[144:147], v[136:139], v[72:87]
  ds_read_b64_tr_b16 v[126:127], v40 offset:26112
  ds_read_b64_tr_b16 v[128:129], v40 offset:24704
  ds_read_b64_tr_b16 v[130:131], v40 offset:26240
  s_add_u32 s72, s72, 196608
  s_cmp_eq_u32 s72, 1572864
  s_cselect_b32 s72, 0, s72
  s_add_u32 s85, s68, s72
  s_add_u32 m0, s70, 0
  s_nop 0
  buffer_load_dwordx4 v4, s[44:47], s85 offen lds
  v_mfma_f32_32x32x16_bf16 v[88:103], v[136:139], v[148:151], v[88:103]
  ds_read_b64_tr_b16 v[132:133], v40 offset:24832
  ds_read_b64_tr_b16 v[134:135], v40 offset:26368
  v_mfma_f32_32x32x16_bf16 v[56:71], v[108:111], v[104:107], v[56:71]
  ds_read_b128 v[136:139], v37 offset:16384
  ds_read_b64_tr_b16 v[140:141], v40 offset:30720
  s_add_u32 m0, s70, 1024
  s_nop 0
  buffer_load_dwordx4 v5, s[44:47], s85 offen lds
  v_mfma_f32_32x32x16_bf16 v[72:87], v[112:115], v[104:107], v[72:87]
  ds_read_b64_tr_b16 v[142:143], v40 offset:32256
  ds_read_b64_tr_b16 v[144:145], v40 offset:30848
  ds_read_b64_tr_b16 v[146:147], v40 offset:32384
  s_add_u32 m0, s70, 2048
  s_nop 0
  buffer_load_dwordx4 v6, s[44:47], s85 offen lds
  v_mfma_f32_32x32x16_bf16 v[88:103], v[104:107], v[116:119], v[88:103]
  ds_read_b64_tr_b16 v[148:149], v40 offset:30976
  ds_read_b64_tr_b16 v[150:151], v40 offset:32512
  s_waitcnt lgkmcnt(11)
  v_mfma_f32_32x32x16_bf16 v[56:71], v[124:127], v[120:123], v[56:71]
  ds_read_b128 v[104:107], v38 offset:16384
  ds_read_b64_tr_b16 v[108:109], v40 offset:36864
  s_add_u32 s71, s71, 128
  s_and_b32 s71, s71, 0x3ff
  s_add_u32 s73, s66, s71
  s_add_u32 m0, s69, 0
  s_nop 0
  buffer_load_dwordx4 v2, s[40:43], s73 offen lds
  s_waitcnt lgkmcnt(11)
  v_mfma_f32_32x32x16_bf16 v[72:87], v[128:131], v[120:123], v[72:87]
  ds_read_b64_tr_b16 v[110:111], v40 offset:38400
  ds_read_b64_tr_b16 v[112:113], v40 offset:36992
  ds_read_b64_tr_b16 v[114:115], v40 offset:38528
  s_add_u32 m0, s69, 1024
  s_nop 0
  buffer_load_dwordx4 v3, s[40:43], s73 offen lds
  s_waitcnt lgkmcnt(12)
  v_mfma_f32_32x32x16_bf16 v[88:103], v[120:123], v[132:135], v[88:103]
  ds_read_b64_tr_b16 v[116:117], v40 offset:37120
  ds_read_b64_tr_b16 v[118:119], v40 offset:38656
  ds_read_b64_tr_b16 v[156:157], v164 offset:0
  s_waitcnt lgkmcnt(14)
  ds_read_b64_tr_b16 v[158:159], v164 offset:256
  s_waitcnt lgkmcnt(14)
  ds_read_b64_tr_b16 v[160:161], v164 offset:512
  s_waitcnt lgkmcnt(14)
  ds_read_b64_tr_b16 v[162:163], v164 offset:768
  v_mfma_f32_32x32x16_bf16 v[56:71], v[140:143], v[136:139], v[56:71]
  s_waitcnt lgkmcnt(14)
  ds_read_b128 v[120:123], v39 offset:16384
  s_waitcnt lgkmcnt(14)
  ds_read_b64_tr_b16 v[124:125], v40 offset:43008
  v_mfma_f32_32x32x16_bf16 v[72:87], v[144:147], v[136:139], v[72:87]
  s_waitcnt lgkmcnt(14)
  ds_read_b64_tr_b16 v[126:127], v40 offset:44544
  s_waitcnt lgkmcnt(14)
  ds_read_b64_tr_b16 v[128:129], v40 offset:43136
  s_waitcnt lgkmcnt(14)
  ds_read_b64_tr_b16 v[130:131], v40 offset:44672
  v_mfma_f32_32x32x16_bf16 v[88:103], v[136:139], v[148:151], v[88:103]
  s_waitcnt lgkmcnt(14)
  ds_read_b64_tr_b16 v[132:133], v40 offset:43264
  s_waitcnt lgkmcnt(14)
  ds_read_b64_tr_b16 v[134:135], v40 offset:44800
  s_waitcnt lgkmcnt(10)
  v_xor_b32 v156, v156, v165
  v_xor_b32 v157, v157, v165
  s_waitcnt lgkmcnt(9)
  v_xor_b32 v158, v158, v165
  v_xor_b32 v159, v159, v165
  s_waitcnt vmcnt(7)
  s_waitcnt vmcnt(5)
  s_waitcnt lgkmcnt(0)
  s_barrier
  v_mfma_f32_32x32x16_bf16 v[56:71], v[108:111], v[104:107], v[56:71]
  ds_read_b128 v[136:139], v36 offset:32768
  ds_read_b64_tr_b16 v[140:141], v41 offset:0
  s_add_u32 s72, s72, 196608
  s_cmp_eq_u32 s72, 1572864
  s_cselect_b32 s72, 0, s72
  s_add_u32 s85, s68, s72
  s_add_u32 m0, s70, 24576
  s_nop 0
  buffer_load_dwordx4 v4, s[44:47], s85 offen lds
  v_mfma_f32_32x32x16_bf16 v[72:87], v[112:115], v[104:107], v[72:87]
  ds_read_b64_tr_b16 v[142:143], v41 offset:1536
  ds_read_b64_tr_b16 v[144:145], v41 offset:128
  ds_read_b64_tr_b16 v[146:147], v41 offset:1664
  s_add_u32 m0, s70, 25600
  s_nop 0
  buffer_load_dwordx4 v5, s[44:47], s85 offen lds
  v_mfma_f32_32x32x16_bf16 v[88:103], v[104:107], v[116:119], v[88:103]
  ds_read_b64_tr_b16 v[148:149], v41 offset:256
  ds_read_b64_tr_b16 v[150:151], v41 offset:1792
  v_xor_b32 v160, v160, v165
  v_xor_b32 v161, v161, v165
  v_xor_b32 v162, v162, v165
  v_xor_b32 v163, v163, v165
  v_mfma_f32_32x32x16_bf16 v[56:71], v[124:127], v[120:123], v[56:71]
  ds_read_b128 v[104:107], v37 offset:32768
  ds_read_b64_tr_b16 v[108:109], v41 offset:6144
  s_add_u32 m0, s70, 26624
  s_nop 0
  buffer_load_dwordx4 v6, s[44:47], s85 offen lds
  v_mfma_f32_32x32x16_bf16 v[72:87], v[128:131], v[120:123], v[72:87]
  ds_read_b64_tr_b16 v[110:111], v41 offset:7680
  ds_read_b64_tr_b16 v[112:113], v41 offset:6272
  ds_read_b64_tr_b16 v[114:115], v41 offset:7808
  s_add_u32 s71, s71, 128
  s_and_b32 s71, s71, 0x3ff
  s_add_u32 s73, s66, s71
  s_add_u32 m0, s69, 16384
  s_nop 0
  buffer_load_dwordx4 v2, s[40:43], s73 offen lds
  v_mfma_f32_32x32x16_bf16 v[88:103], v[120:123], v[132:135], v[88:103]
  ds_read_b64_tr_b16 v[116:117], v41 offset:6400
  ds_read_b64_tr_b16 v[118:119], v41 offset:7936
  s_waitcnt lgkmcnt(11)
  v_mfma_f32_32x32x16_bf16 v[56:71], v[140:143], v[136:139], v[56:71]
  ds_read_b128 v[120:123], v38 offset:32768
  ds_read_b64_tr_b16 v[124:125], v41 offset:12288
  s_add_u32 m0, s69, 17408
  s_nop 0
  buffer_load_dwordx4 v3, s[40:43], s73 offen lds
  s_waitcnt lgkmcnt(11)
  v_mfma_f32_32x32x16_bf16 v[72:87], v[144:147], v[136:139], v[72:87]
  ds_read_b64_tr_b16 v[126:127], v41 offset:13824
  ds_read_b64_tr_b16 v[128:129], v41 offset:12416
  ds_read_b64_tr_b16 v[130:131], v41 offset:13952
  s_waitcnt lgkmcnt(12)
  v_mfma_f32_32x32x16_bf16 v[88:103], v[136:139], v[148:151], v[88:103]
  ds_read_b64_tr_b16 v[132:133], v41 offset:12544
  ds_read_b64_tr_b16 v[134:135], v41 offset:14080
  s_waitcnt lgkmcnt(11)
  v_mfma_f32_32x32x16_bf16 v[56:71], v[108:111], v[104:107], v[56:71]
  ds_read_b128 v[136:139], v39 offset:32768
  ds_read_b64_tr_b16 v[140:141], v41 offset:18432
  s_waitcnt lgkmcnt(11)
  v_mfma_f32_32x32x16_bf16 v[72:87], v[112:115], v[104:107], v[72:87]
  ds_read_b64_tr_b16 v[142:143], v41 offset:19968
  ds_read_b64_tr_b16 v[144:145], v41 offset:18560
  ds_read_b64_tr_b16 v[146:147], v41 offset:20096
  s_waitcnt lgkmcnt(12)
  v_mfma_f32_32x32x16_bf16 v[88:103], v[104:107], v[116:119], v[88:103]
  ds_read_b64_tr_b16 v[148:149], v41 offset:18688
  ds_read_b64_tr_b16 v[150:151], v41 offset:20224
  s_waitcnt vmcnt(7)
  s_waitcnt vmcnt(5)
  s_waitcnt lgkmcnt(0)
  s_barrier
  v_mfma_f32_32x32x16_bf16 v[56:71], v[124:127], v[120:123], v[56:71]
  ds_read_b128 v[104:107], v36 offset:0
  ds_read_b64_tr_b16 v[108:109], v40 offset:0
  s_add_u32 s72, s72, 196608
  s_cmp_eq_u32 s72, 1572864
  s_cselect_b32 s72, 0, s72
  s_add_u32 s85, s68, s72
  s_add_u32 m0, s70, 49152
  s_nop 0
  buffer_load_dwordx4 v4, s[44:47], s85 offen lds
  v_mfma_f32_32x32x16_bf16 v[72:87], v[128:131], v[120:123], v[72:87]
  ds_read_b64_tr_b16 v[110:111], v40 offset:1536
  ds_read_b64_tr_b16 v[112:113], v40 offset:128
  ds_read_b64_tr_b16 v[114:115], v40 offset:1664
  s_add_u32 m0, s70, 50176
  s_nop 0
  buffer_load_dwordx4 v5, s[44:47], s85 offen lds
  v_mfma_f32_32x32x16_bf16 v[88:103], v[120:123], v[132:135], v[88:103]
  ds_read_b64_tr_b16 v[116:117], v40 offset:256
  ds_read_b64_tr_b16 v[118:119], v40 offset:1792
  v_mfma_f32_32x32x16_bf16 v[56:71], v[140:143], v[136:139], v[56:71]
  ds_read_b128 v[120:123], v37 offset:0
  ds_read_b64_tr_b16 v[124:125], v40 offset:6144
  s_add_u32 m0, s70, 51200
  s_nop 0
  buffer_load_dwordx4 v6, s[44:47], s85 offen lds
  v_mfma_f32_32x32x16_bf16 v[72:87], v[144:147], v[136:139], v[72:87]
  ds_read_b64_tr_b16 v[126:127], v40 offset:7680
  ds_read_b64_tr_b16 v[128:129], v40 offset:6272
  ds_read_b64_tr_b16 v[130:131], v40 offset:7808
  s_add_u32 s71, s71, 128
  s_and_b32 s71, s71, 0x3ff
  s_add_u32 s73, s66, s71
  s_add_u32 m0, s69, 32768
  s_nop 0
  buffer_load_dwordx4 v2, s[40:43], s73 offen lds
  v_mfma_f32_32x32x16_bf16 v[88:103], v[136:139], v[148:151], v[88:103]
  ds_read_b64_tr_b16 v[132:133], v40 offset:6400
  ds_read_b64_tr_b16 v[134:135], v40 offset:7936
  s_cmp_eq_u32 s84, 1
  s_cbranch_scc1 L_mix_kernel_A_ev8
L_mix_kernel_A_ev8ret:
  s_waitcnt lgkmcnt(11)
  v_mfma_f32_32x32x16_bf16 v[56:71], v[108:111], v[104:107], v[56:71]
  ds_read_b128 v[136:139], v38 offset:0
  ds_read_b64_tr_b16 v[140:141], v40 offset:12288
  s_add_u32 m0, s69, 33792
  s_nop 0
  buffer_load_dwordx4 v3, s[40:43], s73 offen lds
  s_waitcnt lgkmcnt(11)
  v_mfma_f32_32x32x16_bf16 v[72:87], v[112:115], v[104:107], v[72:87]
  ds_read_b64_tr_b16 v[142:143], v40 offset:13824
  ds_read_b64_tr_b16 v[144:145], v40 offset:12416
  ds_read_b64_tr_b16 v[146:147], v40 offset:13952
  s_waitcnt lgkmcnt(12)
  v_mfma_f32_32x32x16_bf16 v[88:103], v[104:107], v[116:119], v[88:103]
  ds_read_b64_tr_b16 v[148:149], v40 offset:12544
  ds_read_b64_tr_b16 v[150:151], v40 offset:14080
  s_waitcnt lgkmcnt(11)
  v_mfma_f32_32x32x16_bf16 v[56:71], v[124:127], v[120:123], v[56:71]
  ds_read_b128 v[104:107], v39 offset:0
  ds_read_b64_tr_b16 v[108:109], v40 offset:18432
  s_waitcnt lgkmcnt(11)
  v_mfma_f32_32x32x16_bf16 v[72:87], v[128:131], v[120:123], v[72:87]
  ds_read_b64_tr_b16 v[110:111], v40 offset:19968
  ds_read_b64_tr_b16 v[112:113], v40 offset:18560
  ds_read_b64_tr_b16 v[114:115], v40 offset:20096
  s_waitcnt lgkmcnt(12)
  v_mfma_f32_32x32x16_bf16 v[88:103], v[120:123], v[132:135], v[88:103]
  ds_read_b64_tr_b16 v[116:117], v40 offset:18688
  ds_read_b64_tr_b16 v[118:119], v40 offset:20224
  s_waitcnt vmcnt(7)
  s_waitcnt vmcnt(5)
  s_waitcnt lgkmcnt(0)
  s_barrier
  v_mfma_f32_32x32x16_bf16 v[56:71], v[140:143], v[136:139], v[56:71]
  ds_read_b128 v[120:123], v36 offset:16384
  ds_read_b64_tr_b16 v[124:125], v40 offset:24576
  s_add_u32 s72, s72, 196608
  s_cmp_eq_u32 s72, 1572864
  s_cselect_b32 s72, 0, s72
  s_add_u32 s85, s68, s72
  s_add_u32 m0, s70, 0
  s_nop 0
  buffer_load_dwordx4 v4, s[44:47], s85 offen lds
  v_mfma_f32_32x32x16_bf16 v[72:87], v[144:147], v[136:139], v[72:87]
  ds_read_b64_tr_b16 v[126:127], v40 offset:26112
  ds_read_b64_tr_b16 v[128:129], v40 offset:24704
  ds_read_b64_tr_b16 v[130:131], v40 offset:26240
  s_add_u32 m0, s70, 1024
  s_nop 0
  buffer_load_dwordx4 v5, s[44:47], s85 offen lds
  v_mfma_f32_32x32x16_bf16 v[88:103], v[136:139], v[148:151], v[88:103]
  ds_read_b64_tr_b16 v[132:133], v40 offset:24832
  ds_read_b64_tr_b16 v[134:135], v40 offset:26368
  v_mfma_f32_32x32x16_bf16 v[56:71], v[108:111], v[104:107], v[56:71]
  ds_read_b128 v[136:139], v37 offset:16384
  ds_read_b64_tr_b16 v[140:141], v40 offset:30720
  s_add_u32 m0, s70, 2048
  s_nop 0
  buffer_load_dwordx4 v6, s[44:47], s85 offen lds
  v_mfma_f32_32x32x16_bf16 v[72:87], v[112:115], v[104:107], v[72:87]
  ds_read_b64_tr_b16 v[142:143], v40 offset:32256
  ds_read_b64_tr_b16 v[144:145], v40 offset:30848
  ds_read_b64_tr_b16 v[146:147], v40 offset:32384
  s_add_u32 s71, s71, 128
  s_and_b32 s71, s71, 0x3ff
  s_add_u32 s73, s66, s71
  s_add_u32 m0, s69, 0
  s_nop 0
  buffer_load_dwordx4 v2, s[40:43], s73 offen lds
  v_mfma_f32_32x32x16_bf16 v[88:103], v[104:107], v[116:119], v[88:103]
  ds_read_b64_tr_b16 v[148:149], v40 offset:30976
  ds_read_b64_tr_b16 v[150:151], v40 offset:32512
  s_waitcnt lgkmcnt(11)
  v_mfma_f32_32x32x16_bf16 v[56:71], v[124:127], v[120:123], v[56:71]
  ds_read_b128 v[104:107], v38 offset:16384
  ds_read_b64_tr_b16 v[108:109], v40 offset:36864
  s_add_u32 m0, s69, 1024
  s_nop 0
  buffer_load_dwordx4 v3, s[40:43], s73 offen lds
  s_waitcnt lgkmcnt(11)
  v_mfma_f32_32x32x16_bf16 v[72:87], v[128:131], v[120:123], v[72:87]
  ds_read_b64_tr_b16 v[110:111], v40 offset:38400
  ds_read_b64_tr_b16 v[112:113], v40 offset:36992
  ds_read_b64_tr_b16 v[114:115], v40 offset:38528
  s_waitcnt lgkmcnt(12)
  v_mfma_f32_32x32x16_bf16 v[88:103], v[120:123], v[132:135], v[88:103]
  ds_read_b64_tr_b16 v[116:117], v40 offset:37120
  ds_read_b64_tr_b16 v[118:119], v40 offset:38656
  s_waitcnt lgkmcnt(11)
  v_mfma_f32_32x32x16_bf16 v[56:71], v[140:143], v[136:139], v[56:71]
  ds_read_b128 v[120:123], v39 offset:16384
  ds_read_b64_tr_b16 v[124:125], v40 offset:43008
  s_waitcnt lgkmcnt(11)
  v_mfma_f32_32x32x16_bf16 v[72:87], v[144:147], v[136:139], v[72:87]
  ds_read_b64_tr_b16 v[126:127], v40 offset:44544
  ds_read_b64_tr_b16 v[128:129], v40 offset:43136
  ds_read_b64_tr_b16 v[130:131], v40 offset:44672
  s_waitcnt lgkmcnt(12)
  v_mfma_f32_32x32x16_bf16 v[88:103], v[136:139], v[148:151], v[88:103]
  ds_read_b64_tr_b16 v[132:133], v40 offset:43264
  ds_read_b64_tr_b16 v[134:135], v40 offset:44800
  s_waitcnt vmcnt(7)
  s_waitcnt vmcnt(5)
  s_waitcnt lgkmcnt(0)
  s_barrier
  v_mfma_f32_32x32x16_bf16 v[56:71], v[108:111], v[104:107], v[56:71]
  ds_read_b128 v[136:139], v36 offset:32768
  ds_read_b64_tr_b16 v[140:141], v41 offset:0
  s_add_u32 s72, s72, 196608
  s_cmp_eq_u32 s72, 1572864
  s_cselect_b32 s72, 0, s72
  s_add_u32 s85, s68, s72
  s_add_u32 m0, s70, 24576
  s_nop 0
  buffer_load_dwordx4 v4, s[44:47], s85 offen lds
  v_mfma_f32_32x32x16_bf16 v[72:87], v[112:115], v[104:107], v[72:87]
  ds_read_b64_tr_b16 v[142:143], v41 offset:1536
  ds_read_b64_tr_b16 v[144:145], v41 offset:128
  ds_read_b64_tr_b16 v[146:147], v41 offset:1664
  s_add_u32 m0, s70, 25600
  s_nop 0
  buffer_load_dwordx4 v5, s[44:47], s85 offen lds
  v_mfma_f32_32x32x16_bf16 v[88:103], v[104:107], v[116:119], v[88:103]
  ds_read_b64_tr_b16 v[148:149], v41 offset:256
  ds_read_b64_tr_b16 v[150:151], v41 offset:1792
  v_mfma_f32_32x32x16_bf16 v[56:71], v[124:127], v[120:123], v[56:71]
  ds_read_b128 v[104:107], v37 offset:32768
  ds_read_b64_tr_b16 v[108:109], v41 offset:6144
  s_add_u32 m0, s70, 26624
  s_nop 0
  buffer_load_dwordx4 v6, s[44:47], s85 offen lds
  v_mfma_f32_32x32x16_bf16 v[72:87], v[128:131], v[120:123], v[72:87]
  ds_read_b64_tr_b16 v[110:111], v41 offset:7680
  ds_read_b64_tr_b16 v[112:113], v41 offset:6272
  ds_read_b64_tr_b16 v[114:115], v41 offset:7808
  s_add_u32 s71, s71, 128
  s_and_b32 s71, s71, 0x3ff
  s_add_u32 s73, s66, s71
  s_add_u32 m0, s69, 16384
  s_nop 0
  buffer_load_dwordx4 v2, s[40:43], s73 offen lds
  v_mfma_f32_32x32x16_bf16 v[88:103], v[120:123], v[132:135], v[88:103]
  ds_read_b64_tr_b16 v[116:117], v41 offset:6400
  ds_read_b64_tr_b16 v[118:119], v41 offset:7936
  s_waitcnt lgkmcnt(11)
  v_mfma_f32_32x32x16_bf16 v[56:71], v[140:143], v[136:139], v[56:71]
  ds_read_b128 v[120:123], v38 offset:32768
  ds_read_b64_tr_b16 v[124:125], v41 offset:12288
  s_add_u32 m0, s69, 17408
  s_nop 0
  buffer_load_dwordx4 v3, s[40:43], s73 offen lds
  s_waitcnt lgkmcnt(11)
  v_mfma_f32_32x32x16_bf16 v[72:87], v[144:147], v[136:139], v[72:87]
  ds_read_b64_tr_b16 v[126:127], v41 offset:13824
  ds_read_b64_tr_b16 v[128:129], v41 offset:12416
  ds_read_b64_tr_b16 v[130:131], v41 offset:13952
  s_waitcnt lgkmcnt(12)
  v_mfma_f32_32x32x16_bf16 v[88:103], v[136:139], v[148:151], v[88:103]
  ds_read_b64_tr_b16 v[132:133], v41 offset:12544
  ds_read_b64_tr_b16 v[134:135], v41 offset:14080
  s_waitcnt lgkmcnt(11)
  v_mfma_f32_32x32x16_bf16 v[56:71], v[108:111], v[104:107], v[56:71]
  ds_read_b128 v[136:139], v39 offset:32768
  ds_read_b64_tr_b16 v[140:141], v41 offset:18432
  s_waitcnt lgkmcnt(11)
  v_mfma_f32_32x32x16_bf16 v[72:87], v[112:115], v[104:107], v[72:87]
  ds_read_b64_tr_b16 v[142:143], v41 offset:19968
  ds_read_b64_tr_b16 v[144:145], v41 offset:18560
  ds_read_b64_tr_b16 v[146:147], v41 offset:20096
  s_waitcnt lgkmcnt(12)
  v_mfma_f32_32x32x16_bf16 v[88:103], v[104:107], v[116:119], v[88:103]
  ds_read_b64_tr_b16 v[148:149], v41 offset:18688
  ds_read_b64_tr_b16 v[150:151], v41 offset:20224
  s_waitcnt vmcnt(7)
  s_waitcnt vmcnt(5)
  s_waitcnt lgkmcnt(0)
  s_barrier
  v_mfma_f32_32x32x16_bf16 v[56:71], v[124:127], v[120:123], v[56:71]
  ds_read_b128 v[104:107], v36 offset:0
  ds_read_b64_tr_b16 v[108:109], v40 offset:0
  v_mfma_f32_32x32x16_bf16 v[72:87], v[128:131], v[120:123], v[72:87]
  ds_read_b64_tr_b16 v[110:111], v40 offset:1536
  ds_read_b64_tr_b16 v[112:113], v40 offset:128
  ds_read_b64_tr_b16 v[114:115], v40 offset:1664
  v_mfma_f32_32x32x16_bf16 v[88:103], v[120:123], v[132:135], v[88:103]
  ds_read_b64_tr_b16 v[116:117], v40 offset:256
  ds_read_b64_tr_b16 v[118:119], v40 offset:1792
  v_mfma_f32_32x32x16_bf16 v[56:71], v[140:143], v[136:139], v[56:71]
  ds_read_b128 v[120:123], v37 offset:0
  ds_read_b64_tr_b16 v[124:125], v40 offset:6144
  v_mfma_f32_32x32x16_bf16 v[72:87], v[144:147], v[136:139], v[72:87]
  ds_read_b64_tr_b16 v[126:127], v40 offset:7680
  ds_read_b64_tr_b16 v[128:129], v40 offset:6272
  ds_read_b64_tr_b16 v[130:131], v40 offset:7808
  v_mfma_f32_32x32x16_bf16 v[88:103], v[136:139], v[148:151], v[88:103]
  ds_read_b64_tr_b16 v[132:133], v40 offset:6400
  ds_read_b64_tr_b16 v[134:135], v40 offset:7936
  s_waitcnt lgkmcnt(11)
  v_mfma_f32_32x32x16_bf16 v[56:71], v[108:111], v[104:107], v[56:71]
  ds_read_b128 v[136:139], v38 offset:0
  ds_read_b64_tr_b16 v[140:141], v40 offset:12288
  s_waitcnt lgkmcnt(11)
  v_mfma_f32_32x32x16_bf16 v[72:87], v[112:115], v[104:107], v[72:87]
  ds_read_b64_tr_b16 v[142:143], v40 offset:13824
  ds_read_b64_tr_b16 v[144:145], v40 offset:12416
  ds_read_b64_tr_b16 v[146:147], v40 offset:13952
  s_waitcnt lgkmcnt(12)
  v_mfma_f32_32x32x16_bf16 v[88:103], v[104:107], v[116:119], v[88:103]
  ds_read_b64_tr_b16 v[148:149], v40 offset:12544
  ds_read_b64_tr_b16 v[150:151], v40 offset:14080
  s_waitcnt lgkmcnt(11)
  v_mfma_f32_32x32x16_bf16 v[56:71], v[124:127], v[120:123], v[56:71]
  ds_read_b128 v[104:107], v39 offset:0
  ds_read_b64_tr_b16 v[108:109], v40 offset:18432
  s_waitcnt lgkmcnt(11)
  v_mfma_f32_32x32x16_bf16 v[72:87], v[128:131], v[120:123], v[72:87]
  ds_read_b64_tr_b16 v[110:111], v40 offset:19968
  ds_read_b64_tr_b16 v[112:113], v40 offset:18560
  ds_read_b64_tr_b16 v[114:115], v40 offset:20096
  s_waitcnt lgkmcnt(12)
  v_mfma_f32_32x32x16_bf16 v[88:103], v[120:123], v[132:135], v[88:103]
  ds_read_b64_tr_b16 v[116:117], v40 offset:18688
  ds_read_b64_tr_b16 v[118:119], v40 offset:20224
  s_waitcnt vmcnt(2)
  s_waitcnt vmcnt(0)
  s_waitcnt lgkmcnt(0)
  s_barrier
  v_mfma_f32_32x32x16_bf16 v[56:71], v[140:143], v[136:139], v[56:71]
  ds_read_b128 v[120:123], v36 offset:16384
  ds_read_b64_tr_b16 v[124:125], v40 offset:24576
  v_mfma_f32_32x32x16_bf16 v[72:87], v[144:147], v[136:139], v[72:87]
  ds_read_b64_tr_b16 v[126:127], v40 offset:26112
  ds_read_b64_tr_b16 v[128:129], v40 offset:24704
  ds_read_b64_tr_b16 v[130:131], v40 offset:26240
  v_mfma_f32_32x32x16_bf16 v[88:103], v[136:139], v[148:151], v[88:103]
  ds_read_b64_tr_b16 v[132:133], v40 offset:24832
  ds_read_b64_tr_b16 v[134:135], v40 offset:26368
  s_cmp_eq_u32 s78, 0
  s_cbranch_scc1 L_mix_kernel_A_poll0
L_mix_kernel_A_poll0ret:
  v_mfma_f32_32x32x16_bf16 v[56:71], v[108:111], v[104:107], v[56:71]
  ds_read_b128 v[136:139], v37 offset:16384
  ds_read_b64_tr_b16 v[140:141], v40 offset:30720
  v_mfma_f32_32x32x16_bf16 v[72:87], v[112:115], v[104:107], v[72:87]
  ds_read_b64_tr_b16 v[142:143], v40 offset:32256
  ds_read_b64_tr_b16 v[144:145], v40 offset:30848
  ds_read_b64_tr_b16 v[146:147], v40 offset:32384
  v_mfma_f32_32x32x16_bf16 v[88:103], v[104:107], v[116:119], v[88:103]
  ds_read_b64_tr_b16 v[148:149], v40 offset:30976
  ds_read_b64_tr_b16 v[150:151], v40 offset:32512
  s_lshl_b32 s39, s82, 10
  buffer_load_dwordx4 v[12:15], v28, s[40:43], s39 offen
  buffer_load_dwordx4 v[16:19], v28, s[40:43], s39 offen offset:16
  s_waitcnt lgkmcnt(11)
  v_mfma_f32_32x32x16_bf16 v[56:71], v[124:127], v[120:123], v[56:71]
  ds_read_b128 v[104:107], v38 offset:16384
  ds_read_b64_tr_b16 v[108:109], v40 offset:36864
  s_waitcnt lgkmcnt(11)
  v_mfma_f32_32x32x16_bf16 v[72:87], v[128:131], v[120:123], v[72:87]
  ds_read_b64_tr_b16 v[110:111], v40 offset:38400
  ds_read_b64_tr_b16 v[112:113], v40 offset:36992
  ds_read_b64_tr_b16 v[114:115], v40 offset:38528
  s_waitcnt lgkmcnt(12)
  v_mfma_f32_32x32x16_bf16 v[88:103], v[120:123], v[132:135], v[88:103]
  ds_read_b64_tr_b16 v[116:117], v40 offset:37120
  ds_read_b64_tr_b16 v[118:119], v40 offset:38656
  s_waitcnt lgkmcnt(11)
  v_mfma_f32_32x32x16_bf16 v[56:71], v[140:143], v[136:139], v[56:71]
  ds_read_b128 v[120:123], v39 offset:16384
  ds_read_b64_tr_b16 v[124:125], v40 offset:43008
  s_waitcnt lgkmcnt(11)
  v_mfma_f32_32x32x16_bf16 v[72:87], v[144:147], v[136:139], v[72:87]
  ds_read_b64_tr_b16 v[126:127], v40 offset:44544
  ds_read_b64_tr_b16 v[128:129], v40 offset:43136
  ds_read_b64_tr_b16 v[130:131], v40 offset:44672
  s_waitcnt lgkmcnt(12)
  v_mfma_f32_32x32x16_bf16 v[88:103], v[136:139], v[148:151], v[88:103]
  ds_read_b64_tr_b16 v[132:133], v40 offset:43264
  ds_read_b64_tr_b16 v[134:135], v40 offset:44800
  s_waitcnt lgkmcnt(11)
  v_mfma_f32_32x32x16_bf16 v[56:71], v[108:111], v[104:107], v[56:71]
  s_waitcnt lgkmcnt(9)
  v_mfma_f32_32x32x16_bf16 v[72:87], v[112:115], v[104:107], v[72:87]
  s_waitcnt lgkmcnt(7)
  v_mfma_f32_32x32x16_bf16 v[88:103], v[104:107], v[116:119], v[88:103]
  s_waitcnt lgkmcnt(4)
  v_mfma_f32_32x32x16_bf16 v[56:71], v[124:127], v[120:123], v[56:71]
  s_waitcnt lgkmcnt(2)
  v_mfma_f32_32x32x16_bf16 v[72:87], v[128:131], v[120:123], v[72:87]
  s_waitcnt lgkmcnt(0)
  v_mfma_f32_32x32x16_bf16 v[88:103], v[120:123], v[132:135], v[88:103]
  s_nop 9
  v_cvt_pk_bf16_f32 v136, v72, v73
  v_cvt_pk_bf16_f32 v137, v74, v75
  v_cvt_pk_bf16_f32 v138, v76, v77
  v_cvt_pk_bf16_f32 v139, v78, v79
  v_cvt_pk_bf16_f32 v140, v80, v81
  v_cvt_pk_bf16_f32 v141, v82, v83
  v_cvt_pk_bf16_f32 v142, v84, v85
  v_cvt_pk_bf16_f32 v143, v86, v87
  v_mfma_f32_32x32x16_bf16 v[184:199], v[156:159], v[136:139], 0
  s_nop 0
  v_mfma_f32_32x32x16_bf16 v[200:215], v[160:163], v[140:143], 0
  v_cvt_pk_bf16_f32 v104, v88, v89
  v_cvt_pk_bf16_f32 v105, v90, v91
  v_cvt_pk_bf16_f32 v106, v92, v93
  v_cvt_pk_bf16_f32 v107, v94, v95
  v_cvt_pk_bf16_f32 v108, v96, v97
  v_cvt_pk_bf16_f32 v109, v98, v99
  v_cvt_pk_bf16_f32 v110, v100, v101
  v_cvt_pk_bf16_f32 v111, v102, v103
  v_cndmask_b32 v88, v166, v104, s[76:77]
  v_cndmask_b32 v89, v166, v105, s[76:77]
  v_cndmask_b32 v90, v166, v106, s[76:77]
  v_cndmask_b32 v91, v166, v107, s[76:77]
  v_cndmask_b32 v92, v166, v108, s[76:77]
  v_cndmask_b32 v93, v166, v109, s[76:77]
  v_cndmask_b32 v94, v166, v110, s[76:77]
  v_cndmask_b32 v95, v166, v111, s[76:77]
  v_cndmask_b32 v96, v104, v166, s[76:77]
  v_cndmask_b32 v97, v105, v166, s[76:77]
  v_cndmask_b32 v98, v106, v166, s[76:77]
  v_cndmask_b32 v99, v107, v166, s[76:77]
  v_cndmask_b32 v100, v108, v166, s[76:77]
  v_cndmask_b32 v101, v109, v166, s[76:77]
  v_cndmask_b32 v102, v110, v166, s[76:77]
  v_cndmask_b32 v103, v111, v166, s[76:77]
  v_max3_f32 v232, v184, v185, v186
  v_max3_f32 v236, v200, v201, v202
  v_max3_f32 v232, v232, v187, v188
  v_max3_f32 v236, v236, v203, v204
  v_max3_f32 v232, v232, v189, v190
  v_max3_f32 v236, v236, v205, v206
  v_max3_f32 v232, v232, v191, v192
  v_max3_f32 v236, v236, v207, v208
  v_max3_f32 v232, v232, v193, v194
  v_max3_f32 v236, v236, v209, v210
  v_max3_f32 v232, v232, v195, v196
  v_max3_f32 v236, v236, v211, v212
  v_max3_f32 v232, v232, v197, v198
  v_max3_f32 v236, v236, v213, v214
  v_max_f32 v232, v232, v199
  v_max_f32 v236, v236, v215
  v_mul_f32 v232, 0xbfb8aa3b, v232
  v_mul_f32 v236, 0xbfb8aa3b, v236
  v_pk_fma_f32 v[184:185], v[184:185], s[74:75], v[232:233] op_sel_hi:[1,1,0]
  v_pk_fma_f32 v[200:201], v[200:201], s[74:75], v[236:237] op_sel_hi:[1,1,0]
  v_pk_fma_f32 v[186:187], v[186:187], s[74:75], v[232:233] op_sel_hi:[1,1,0]
  v_pk_fma_f32 v[202:203], v[202:203], s[74:75], v[236:237] op_sel_hi:[1,1,0]
  v_pk_fma_f32 v[188:189], v[188:189], s[74:75], v[232:233] op_sel_hi:[1,1,0]
  v_pk_fma_f32 v[204:205], v[204:205], s[74:75], v[236:237] op_sel_hi:[1,1,0]
  v_pk_fma_f32 v[190:191], v[190:191], s[74:75], v[232:233] op_sel_hi:[1,1,0]
  v_pk_fma_f32 v[206:207], v[206:207], s[74:75], v[236:237] op_sel_hi:[1,1,0]
  v_pk_fma_f32 v[192:193], v[192:193], s[74:75], v[232:233] op_sel_hi:[1,1,0]
  v_pk_fma_f32 v[208:209], v[208:209], s[74:75], v[236:237] op_sel_hi:[1,1,0]
  v_pk_fma_f32 v[194:195], v[194:195], s[74:75], v[232:233] op_sel_hi:[1,1,0]
  v_pk_fma_f32 v[210:211], v[210:211], s[74:75], v[236:237] op_sel_hi:[1,1,0]
  v_pk_fma_f32 v[196:197], v[196:197], s[74:75], v[232:233] op_sel_hi:[1,1,0]
  v_pk_fma_f32 v[212:213], v[212:213], s[74:75], v[236:237] op_sel_hi:[1,1,0]
  v_pk_fma_f32 v[198:199], v[198:199], s[74:75], v[232:233] op_sel_hi:[1,1,0]
  v_pk_fma_f32 v[214:215], v[214:215], s[74:75], v[236:237] op_sel_hi:[1,1,0]
  v_exp_f32 v184, v184
  v_exp_f32 v200, v200
  v_exp_f32 v185, v185
  v_exp_f32 v201, v201
  v_exp_f32 v186, v186
  v_exp_f32 v202, v202
  v_exp_f32 v187, v187
  v_exp_f32 v203, v203
  v_exp_f32 v188, v188
  v_exp_f32 v204, v204
  v_exp_f32 v189, v189
  v_exp_f32 v205, v205
  v_exp_f32 v190, v190
  v_exp_f32 v206, v206
  v_exp_f32 v191, v191
  v_exp_f32 v207, v207
  v_exp_f32 v192, v192
  v_exp_f32 v208, v208
  v_exp_f32 v193, v193
  v_exp_f32 v209, v209
  v_exp_f32 v194, v194
  v_exp_f32 v210, v210
  v_exp_f32 v195, v195
  v_exp_f32 v211, v211
  v_exp_f32 v196, v196
  v_exp_f32 v212, v212
  v_exp_f32 v197, v197
  v_exp_f32 v213, v213
  v_exp_f32 v198, v198
  v_exp_f32 v214, v214
  v_exp_f32 v199, v199
  v_exp_f32 v215, v215
  v_pk_add_f32 v[234:235], v[184:185], v[186:187]
  v_pk_add_f32 v[238:239], v[200:201], v[202:203]
  v_pk_add_f32 v[234:235], v[234:235], v[188:189]
  v_pk_add_f32 v[238:239], v[238:239], v[204:205]
  v_pk_add_f32 v[234:235], v[234:235], v[190:191]
  v_pk_add_f32 v[238:239], v[238:239], v[206:207]
  v_pk_add_f32 v[234:235], v[234:235], v[192:193]
  v_pk_add_f32 v[238:239], v[238:239], v[208:209]
  v_pk_add_f32 v[234:235], v[234:235], v[194:195]
  v_pk_add_f32 v[238:239], v[238:239], v[210:211]
  v_pk_add_f32 v[234:235], v[234:235], v[196:197]
  v_pk_add_f32 v[238:239], v[238:239], v[212:213]
  v_pk_add_f32 v[234:235], v[234:235], v[198:199]
  v_pk_add_f32 v[238:239], v[238:239], v[214:215]
  v_add_f32 v232, v234, v235
  v_add_f32 v236, v238, v239
  v_rcp_f32 v232, v232
  v_rcp_f32 v236, v236
  v_pk_mul_f32 v[184:185], v[184:185], v[232:233] op_sel_hi:[1,0]
  v_pk_mul_f32 v[200:201], v[200:201], v[236:237] op_sel_hi:[1,0]
  v_pk_mul_f32 v[186:187], v[186:187], v[232:233] op_sel_hi:[1,0]
  v_pk_mul_f32 v[202:203], v[202:203], v[236:237] op_sel_hi:[1,0]
  v_pk_mul_f32 v[188:189], v[188:189], v[232:233] op_sel_hi:[1,0]
  v_pk_mul_f32 v[204:205], v[204:205], v[236:237] op_sel_hi:[1,0]
  v_pk_mul_f32 v[190:191], v[190:191], v[232:233] op_sel_hi:[1,0]
  v_pk_mul_f32 v[206:207], v[206:207], v[236:237] op_sel_hi:[1,0]
  v_pk_mul_f32 v[192:193], v[192:193], v[232:233] op_sel_hi:[1,0]
  v_pk_mul_f32 v[208:209], v[208:209], v[236:237] op_sel_hi:[1,0]
  v_pk_mul_f32 v[194:195], v[194:195], v[232:233] op_sel_hi:[1,0]
  v_pk_mul_f32 v[210:211], v[210:211], v[236:237] op_sel_hi:[1,0]
  v_pk_mul_f32 v[196:197], v[196:197], v[232:233] op_sel_hi:[1,0]
  v_pk_mul_f32 v[212:213], v[212:213], v[236:237] op_sel_hi:[1,0]
  v_pk_mul_f32 v[198:199], v[198:199], v[232:233] op_sel_hi:[1,0]
  v_pk_mul_f32 v[214:215], v[214:215], v[236:237] op_sel_hi:[1,0]
  v_cvt_pk_bf16_f32 v216, v184, v185
  v_cvt_pk_bf16_f32 v224, v200, v201
  v_cvt_pk_bf16_f32 v217, v186, v187
  v_cvt_pk_bf16_f32 v225, v202, v203
  v_cvt_pk_bf16_f32 v218, v188, v189
  v_cvt_pk_bf16_f32 v226, v204, v205
  v_cvt_pk_bf16_f32 v219, v190, v191
  v_cvt_pk_bf16_f32 v227, v206, v207
  v_cvt_pk_bf16_f32 v220, v192, v193
  v_cvt_pk_bf16_f32 v228, v208, v209
  v_cvt_pk_bf16_f32 v221, v194, v195
  v_cvt_pk_bf16_f32 v229, v210, v211
  v_cvt_pk_bf16_f32 v222, v196, v197
  v_cvt_pk_bf16_f32 v230, v212, v213
  v_cvt_pk_bf16_f32 v223, v198, v199
  v_cvt_pk_bf16_f32 v231, v214, v215
  v_mfma_f32_32x32x16_bf16 v[184:199], v[216:219], v[44:47], 0
  v_mfma_f32_32x32x16_bf16 v[200:215], v[224:227], v[44:47], 0
  v_mfma_f32_32x32x16_bf16 v[184:199], v[220:223], v[48:51], v[184:199]
  v_mfma_f32_32x32x16_bf16 v[200:215], v[228:231], v[48:51], v[200:215]
  s_nop 10
  v_cvt_pk_bf16_f32 v216, v184, v185
  v_cvt_pk_bf16_f32 v217, v186, v187
  v_cvt_pk_bf16_f32 v218, v188, v189
  v_cvt_pk_bf16_f32 v219, v190, v191
  v_cvt_pk_bf16_f32 v220, v192, v193
  v_cvt_pk_bf16_f32 v221, v194, v195
  v_cvt_pk_bf16_f32 v222, v196, v197
  v_cvt_pk_bf16_f32 v223, v198, v199
  v_cvt_pk_bf16_f32 v224, v200, v201
  v_cvt_pk_bf16_f32 v225, v202, v203
  v_cvt_pk_bf16_f32 v226, v204, v205
  v_cvt_pk_bf16_f32 v227, v206, v207
  v_cvt_pk_bf16_f32 v228, v208, v209
  v_cvt_pk_bf16_f32 v229, v210, v211
  v_cvt_pk_bf16_f32 v230, v212, v213
  v_cvt_pk_bf16_f32 v231, v214, v215
  v_mfma_f32_32x32x16_bf16 v[184:199], v[216:219], v[88:91], 0
  v_mfma_f32_32x32x16_bf16 v[200:215], v[224:227], v[96:99], 0
  v_mfma_f32_32x32x16_bf16 v[184:199], v[220:223], v[92:95], v[184:199]
  v_mfma_f32_32x32x16_bf16 v[200:215], v[228:231], v[100:103], v[200:215]
  s_nop 10
  ds_write_b128 v172, v[184:187] offset:0
  ds_write_b128 v173, v[188:191] offset:0
  ds_write_b128 v174, v[192:195] offset:0
  ds_write_b128 v175, v[196:199] offset:0
  ds_write_b128 v176, v[200:203] offset:2176
  ds_write_b128 v177, v[204:207] offset:2176
  ds_write_b128 v178, v[208:211] offset:2176
  ds_write_b128 v179, v[212:215] offset:2176
  s_cmp_eq_u32 s78, 0
  s_cbranch_scc1 L_mix_kernel_A_poll
L_mix_kernel_A_flagok:
  s_waitcnt lgkmcnt(0)
  s_barrier
  ds_read_b32 v88, v169 offset:2048
  ds_read_b32 v89, v169 offset:6400
  ds_read_b32 v90, v169 offset:10752
  ds_read_b32 v91, v169 offset:15104
  ds_read_b32 v92, v169 offset:3072
  ds_read_b32 v93, v169 offset:7424
  ds_read_b32 v94, v169 offset:11776
  ds_read_b32 v95, v169 offset:16128
  ds_read_b32 v96, v169 offset:4096
  ds_read_b32 v97, v169 offset:8448
  ds_read_b32 v98, v169 offset:12800
  ds_read_b32 v99, v169 offset:17152
  ds_read_b32 v100, v169 offset:5120
  ds_read_b32 v101, v169 offset:9472
  ds_read_b32 v102, v169 offset:13824
  s_waitcnt lgkmcnt(14)
  ds_read_b32 v103, v169 offset:18176
  s_waitcnt lgkmcnt(14)
  ds_read_b32 v104, v169 offset:6144
  s_waitcnt lgkmcnt(14)
  ds_read_b32 v105, v169 offset:10496
  s_waitcnt lgkmcnt(14)
  ds_read_b32 v106, v169 offset:14848
  s_waitcnt lgkmcnt(14)
  ds_read_b32 v107, v169 offset:19200
  v_add_f32 v88, v88, v89
  v_add_f32 v90, v90, v91
  v_add_f32 v88, v88, v90
  buffer_atomic_add_f32 v88, v168, s[52:55], 0 offen offset:0 sc1
  s_waitcnt lgkmcnt(14)
  v_add_f32 v92, v92, v93
  s_waitcnt lgkmcnt(12)
  v_add_f32 v94, v94, v95
  v_add_f32 v92, v92, v94
  buffer_atomic_add_f32 v92, v168, s[52:55], 0 offen offset:1024 sc1
  s_waitcnt lgkmcnt(10)
  v_add_f32 v96, v96, v97
  s_waitcnt lgkmcnt(8)
  v_add_f32 v98, v98, v99
  v_add_f32 v96, v96, v98
  buffer_atomic_add_f32 v96, v168, s[52:55], 0 offen offset:2048 sc1
  s_waitcnt lgkmcnt(6)
  v_add_f32 v100, v100, v101
  s_waitcnt lgkmcnt(4)
  v_add_f32 v102, v102, v103
  v_add_f32 v100, v100, v102
  buffer_atomic_add_f32 v100, v168, s[52:55], 0 offen offset:3072 sc1
  s_waitcnt lgkmcnt(2)
  v_add_f32 v104, v104, v105
  s_waitcnt lgkmcnt(0)
  v_add_f32 v106, v106, v107
  v_add_f32 v104, v104, v106
  v_add_u32 v7, 4096, v168
  buffer_atomic_add_f32 v104, v7, s[52:55], 0 offen sc1
  v_cvt_pk_bf16_f32 v144, v56, v57
  v_cvt_pk_bf16_f32 v145, v58, v59
  v_cvt_pk_bf16_f32 v146, v60, v61
  v_cvt_pk_bf16_f32 v147, v62, v63
  v_cvt_pk_bf16_f32 v148, v64, v65
  v_cvt_pk_bf16_f32 v149, v66, v67
  v_cvt_pk_bf16_f32 v150, v68, v69
  v_cvt_pk_bf16_f32 v151, v70, v71
  v_mfma_f32_32x32x16_bf16 v[72:87], v[156:159], v[144:147], 0
  s_nop 0
  v_mfma_f32_32x32x16_bf16 v[56:71], v[160:163], v[148:151], 0
  v_mov_b32 v152, 0
  s_waitcnt vmcnt(6)
  v_dot2c_f32_bf16 v152, v12, v20
  v_dot2c_f32_bf16 v152, v13, v21
  v_dot2c_f32_bf16 v152, v14, v22
  v_dot2c_f32_bf16 v152, v15, v23
  s_waitcnt vmcnt(5)
  v_dot2c_f32_bf16 v152, v16, v24
  v_dot2c_f32_bf16 v152, v17, v25
  v_dot2c_f32_bf16 v152, v18, v26
  v_dot2c_f32_bf16 v152, v19, v27
  s_nop 2
  v_add_f32_dpp v152, v152, v152 row_ror:8 row_mask:0xf bank_mask:0xf
  s_nop 1
  v_add_f32_dpp v152, v152, v152 row_ror:4 row_mask:0xf bank_mask:0xf
  s_nop 1
  v_add_f32_dpp v152, v152, v152 row_ror:2 row_mask:0xf bank_mask:0xf
  s_nop 1
  v_add_f32_dpp v152, v152, v152 row_ror:1 row_mask:0xf bank_mask:0xf
  s_nop 1
  v_add_f32_dpp v152, v152, v152 row_bcast:15 row_mask:0xa bank_mask:0xf
  v_cvt_pk_bf16_f32 v152, v152, v152
  v_lshlrev_b32 v152, 16, v152
  v_mul_f32 v152, 0xbfb8aa3b, v152
  v_exp_f32 v152, v152
  s_nop 0
  v_add_f32 v152, 1.0, v152
  v_rcp_f32 v152, v152
  s_nop 0
  v_cvt_pk_bf16_f32 v152, v152, v152
  v_lshlrev_b32 v152, 16, v152
  v_lshlrev_b32 v153, 2, v34
  v_bfe_u32 v154, v1, 4, 1
  v_subrev_u32 v154, 1, v154
  v_and_b32 v154, 0x80000000, v154
  v_or_b32 v153, v153, v154
  s_lshl_b32 s63, s82, 2
  s_add_u32 s63, s63, 6946816
  buffer_store_dword v152, v153, s[48:51], s63 offen sc1
  v_max3_f32 v232, v72, v73, v74
  v_max3_f32 v236, v56, v57, v58
  v_max3_f32 v232, v232, v75, v76
  v_max3_f32 v236, v236, v59, v60
  v_max3_f32 v232, v232, v77, v78
  v_max3_f32 v236, v236, v61, v62
  v_max3_f32 v232, v232, v79, v80
  v_max3_f32 v236, v236, v63, v64
  v_max3_f32 v232, v232, v81, v82
  v_max3_f32 v236, v236, v65, v66
  v_max3_f32 v232, v232, v83, v84
  v_max3_f32 v236, v236, v67, v68
  v_max3_f32 v232, v232, v85, v86
  v_max3_f32 v236, v236, v69, v70
  v_max_f32 v232, v232, v87
  v_max_f32 v236, v236, v71
  v_mul_f32 v232, 0xbfb8aa3b, v232
  v_mul_f32 v236, 0xbfb8aa3b, v236
  v_pk_fma_f32 v[72:73], v[72:73], s[74:75], v[232:233] op_sel_hi:[1,1,0]
  v_pk_fma_f32 v[56:57], v[56:57], s[74:75], v[236:237] op_sel_hi:[1,1,0]
  v_pk_fma_f32 v[74:75], v[74:75], s[74:75], v[232:233] op_sel_hi:[1,1,0]
  v_pk_fma_f32 v[58:59], v[58:59], s[74:75], v[236:237] op_sel_hi:[1,1,0]
  v_pk_fma_f32 v[76:77], v[76:77], s[74:75], v[232:233] op_sel_hi:[1,1,0]
  v_pk_fma_f32 v[60:61], v[60:61], s[74:75], v[236:237] op_sel_hi:[1,1,0]
  v_pk_fma_f32 v[78:79], v[78:79], s[74:75], v[232:233] op_sel_hi:[1,1,0]
  v_pk_fma_f32 v[62:63], v[62:63], s[74:75], v[236:237] op_sel_hi:[1,1,0]
  v_pk_fma_f32 v[80:81], v[80:81], s[74:75], v[232:233] op_sel_hi:[1,1,0]
  v_pk_fma_f32 v[64:65], v[64:65], s[74:75], v[236:237] op_sel_hi:[1,1,0]
  v_pk_fma_f32 v[82:83], v[82:83], s[74:75], v[232:233] op_sel_hi:[1,1,0]
  v_pk_fma_f32 v[66:67], v[66:67], s[74:75], v[236:237] op_sel_hi:[1,1,0]
  v_pk_fma_f32 v[84:85], v[84:85], s[74:75], v[232:233] op_sel_hi:[1,1,0]
  v_pk_fma_f32 v[68:69], v[68:69], s[74:75], v[236:237] op_sel_hi:[1,1,0]
  v_pk_fma_f32 v[86:87], v[86:87], s[74:75], v[232:233] op_sel_hi:[1,1,0]
  v_pk_fma_f32 v[70:71], v[70:71], s[74:75], v[236:237] op_sel_hi:[1,1,0]
  v_exp_f32 v72, v72
  v_exp_f32 v56, v56
  v_exp_f32 v73, v73
  v_exp_f32 v57, v57
  v_exp_f32 v74, v74
  v_exp_f32 v58, v58
  v_exp_f32 v75, v75
  v_exp_f32 v59, v59
  v_exp_f32 v76, v76
  v_exp_f32 v60, v60
  v_exp_f32 v77, v77
  v_exp_f32 v61, v61
  v_exp_f32 v78, v78
  v_exp_f32 v62, v62
  v_exp_f32 v79, v79
  v_exp_f32 v63, v63
  v_exp_f32 v80, v80
  v_exp_f32 v64, v64
  v_exp_f32 v81, v81
  v_exp_f32 v65, v65
  v_exp_f32 v82, v82
  v_exp_f32 v66, v66
  v_exp_f32 v83, v83
  v_exp_f32 v67, v67
  v_exp_f32 v84, v84
  v_exp_f32 v68, v68
  v_exp_f32 v85, v85
  v_exp_f32 v69, v69
  v_exp_f32 v86, v86
  v_exp_f32 v70, v70
  v_exp_f32 v87, v87
  v_exp_f32 v71, v71
  v_pk_add_f32 v[234:235], v[72:73], v[74:75]
  v_pk_add_f32 v[238:239], v[56:57], v[58:59]
  v_pk_add_f32 v[234:235], v[234:235], v[76:77]
  v_pk_add_f32 v[238:239], v[238:239], v[60:61]
  v_pk_add_f32 v[234:235], v[234:235], v[78:79]
  v_pk_add_f32 v[238:239], v[238:239], v[62:63]
  v_pk_add_f32 v[234:235], v[234:235], v[80:81]
  v_pk_add_f32 v[238:239], v[238:239], v[64:65]
  v_pk_add_f32 v[234:235], v[234:235], v[82:83]
  v_pk_add_f32 v[238:239], v[238:239], v[66:67]
  v_pk_add_f32 v[234:235], v[234:235], v[84:85]
  v_pk_add_f32 v[238:239], v[238:239], v[68:69]
  v_pk_add_f32 v[234:235], v[234:235], v[86:87]
  v_pk_add_f32 v[238:239], v[238:239], v[70:71]
  v_add_f32 v232, v234, v235
  v_add_f32 v236, v238, v239
  v_rcp_f32 v232, v232
  v_rcp_f32 v236, v236
  v_pk_mul_f32 v[72:73], v[72:73], v[232:233] op_sel_hi:[1,0]
  v_pk_mul_f32 v[56:57], v[56:57], v[236:237] op_sel_hi:[1,0]
  v_pk_mul_f32 v[74:75], v[74:75], v[232:233] op_sel_hi:[1,0]
  v_pk_mul_f32 v[58:59], v[58:59], v[236:237] op_sel_hi:[1,0]
  v_pk_mul_f32 v[76:77], v[76:77], v[232:233] op_sel_hi:[1,0]
  v_pk_mul_f32 v[60:61], v[60:61], v[236:237] op_sel_hi:[1,0]
  v_pk_mul_f32 v[78:79], v[78:79], v[232:233] op_sel_hi:[1,0]
  v_pk_mul_f32 v[62:63], v[62:63], v[236:237] op_sel_hi:[1,0]
  v_pk_mul_f32 v[80:81], v[80:81], v[232:233] op_sel_hi:[1,0]
  v_pk_mul_f32 v[64:65], v[64:65], v[236:237] op_sel_hi:[1,0]
  v_pk_mul_f32 v[82:83], v[82:83], v[232:233] op_sel_hi:[1,0]
  v_pk_mul_f32 v[66:67], v[66:67], v[236:237] op_sel_hi:[1,0]
  v_pk_mul_f32 v[84:85], v[84:85], v[232:233] op_sel_hi:[1,0]
  v_pk_mul_f32 v[68:69], v[68:69], v[236:237] op_sel_hi:[1,0]
  v_pk_mul_f32 v[86:87], v[86:87], v[232:233] op_sel_hi:[1,0]
  v_pk_mul_f32 v[70:71], v[70:71], v[236:237] op_sel_hi:[1,0]
  v_cvt_pk_bf16_f32 v12, v72, v73
  v_cvt_pk_bf16_f32 v20, v56, v57
  v_cvt_pk_bf16_f32 v13, v74, v75
  v_cvt_pk_bf16_f32 v21, v58, v59
  v_cvt_pk_bf16_f32 v14, v76, v77
  v_cvt_pk_bf16_f32 v22, v60, v61
  v_cvt_pk_bf16_f32 v15, v78, v79
  v_cvt_pk_bf16_f32 v23, v62, v63
  v_cvt_pk_bf16_f32 v16, v80, v81
  v_cvt_pk_bf16_f32 v24, v64, v65
  v_cvt_pk_bf16_f32 v17, v82, v83
  v_cvt_pk_bf16_f32 v25, v66, v67
  v_cvt_pk_bf16_f32 v18, v84, v85
  v_cvt_pk_bf16_f32 v26, v68, v69
  v_cvt_pk_bf16_f32 v19, v86, v87
  v_cvt_pk_bf16_f32 v27, v70, v71
  buffer_store_dwordx4 v[12:15], v31, s[48:51], s81 offen offset:0 sc1
  buffer_store_dwordx4 v[16:19], v31, s[48:51], s81 offen offset:1024 sc1
  buffer_store_dwordx4 v[20:23], v31, s[48:51], s81 offen offset:2048 sc1
  buffer_store_dwordx4 v[24:27], v31, s[48:51], s81 offen offset:3072 sc1
  s_endpgm
L_mix_kernel_A_ev4:
  s_mul_i32 s3, s38, 4352
  s_add_u32 s3, s3, 6815744
  buffer_store_dwordx4 v[52:55], v31, s[48:51], s3 offen offset:0 sc1
  buffer_store_dwordx4 v[52:55], v31, s[48:51], s3 offen offset:1024 sc1
  buffer_store_dwordx4 v[52:55], v31, s[48:51], s3 offen offset:2048 sc1
  buffer_store_dwordx4 v[52:55], v31, s[48:51], s3 offen offset:3072 sc1
  s_add_u32 s3, s3, 4096
  s_mov_b64 exec, 0xffff
  buffer_store_dwordx4 v[52:55], v31, s[48:51], s3 offen sc1
  s_mov_b64 exec, -1
  s_branch L_mix_kernel_A_ev4ret
L_mix_kernel_A_ev8:
  s_waitcnt vmcnt(17)
  v_mov_b32 v32, 1
  s_lshl_b32 s3, s38, 2
  s_add_u32 s3, s3, 64
  s_mov_b64 exec, 1
  buffer_store_dword v32, v30, s[56:59], s3 offen sc1
  s_mov_b64 exec, -1
  s_branch L_mix_kernel_A_ev8ret
L_mix_kernel_A_poll0:
  buffer_load_dword v180, v30, s[56:59], s83 offen sc1
  s_branch L_mix_kernel_A_poll0ret
L_mix_kernel_A_poll:
  s_mov_b32 s80, 0
  s_waitcnt vmcnt(2)
L_mix_kernel_A_poll1:
  v_readfirstlane_b32 s3, v180
  s_nop 0
  s_cmp_lg_u32 s3, 0
  s_cbranch_scc1 L_mix_kernel_A_flagok
  s_add_u32 s80, s80, 1
  s_cmp_ge_u32 s80, 0x40000
  s_cbranch_scc1 L_mix_kernel_A_flagok
  buffer_load_dword v180, v30, s[56:59], s83 offen sc1
  s_waitcnt vmcnt(0)
  s_branch L_mix_kernel_A_poll1
L_mix_kernel_B:
  s_add_u32 s85, s35, 3
  s_and_b32 s85, s85, 7
  s_lshl_b32 s66, s85, 6
  s_lshl_b32 s64, s36, 2
  s_add_u32 s66, s66, s64
  s_lshr_b32 s67, s34, 1
  s_and_b32 s68, s34, 1
  s_lshr_b32 s80, s34, 2
  s_and_b32 s82, s34, 3
  s_lshl_b32 s64, s80, 1
  s_add_u32 s81, s66, s64
  v_and_b32 v1, 63, v0
  s_add_u32 s64, s66, s67
  s_lshl_b32 s64, s64, 8
  v_lshlrev_b32 v14, 2, v1
  v_add_u32 v14, s64, v14
  s_lshl_b32 s65, s81, 1
  s_waitcnt lgkmcnt(0)
  s_load_dword s69, s[22:23], s65
  s_load_dword s70, s[24:25], s65
  global_load_dword v15, v14, s[14:15]
  global_load_dword v16, v14, s[16:17]
  global_load_dword v17, v14, s[18:19]
  global_load_dword v18, v14, s[20:21]
  s_mov_b32 s40, s4
  s_and_b32 s41, s5, 0xffff
  s_mov_b32 s42, 2097152
  s_mov_b32 s43, 0x20000
  v_and_b32 v2, 15, v1
  v_lshlrev_b32 v2, 10, v2
  s_lshl_b32 s64, s36, 7
  s_lshl_b32 s39, s34, 4
  s_add_u32 s64, s64, s39
  s_lshl_b32 s64, s64, 10
  s_lshl_b32 s39, s85, 7
  s_add_u32 s64, s64, s39
  s_mov_b64 exec, 0xffff
  buffer_load_dword v250, v2, s[40:43], s64 offen
  s_mov_b64 exec, -1
  v_lshlrev_b32 v34, 12, v0
  s_lshl_b32 s64, s66, 1
  v_add_u32 v34, s64, v34
  v_subrev_u32 v35, 3072, v34
  s_mov_b32 s48, s32
  s_and_b32 s49, s33, 0xffff
  s_mov_b32 s50, 8388608
  s_mov_b32 s51, 0x20000
  s_mul_i32 s71, s67, 31744
  s_mov_b32 s76, s71
  v_and_b32 v2, 1, v1
  v_lshlrev_b32 v2, 3, v2
  v_lshrrev_b32 v3, 1, v1
  v_lshl_add_u32 v2, v3, 4, v2
  v_add_u32 v36, s76, v2
  v_xor_b32 v37, 16, v36
  v_xor_b32 v38, 32, v36
  v_xor_b32 v39, 48, v36
  v_xor_b32 v40, 64, v36
  v_xor_b32 v41, 80, v36
  v_xor_b32 v42, 96, v36
  v_xor_b32 v43, 112, v36
  v_xor_b32 v44, 128, v36
  v_xor_b32 v45, 144, v36
  v_xor_b32 v46, 160, v36
  v_xor_b32 v47, 176, v36
  v_xor_b32 v48, 192, v36
  v_xor_b32 v49, 208, v36
  v_xor_b32 v50, 224, v36
  v_xor_b32 v51, 240, v36
  v_and_b32 v10, 15, v1
  v_lshrrev_b32 v11, 4, v1
  v_and_b32 v2, 15, v10
  v_xor_b32 v2, v2, v11
  v_lshlrev_b32 v2, 4, v2
  v_lshl_add_u32 v2, v10, 9, v2
  v_add_u32 v52, s76, v2
  v_xor_b32 v53, 64, v52
  v_xor_b32 v54, 128, v52
  v_xor_b32 v55, 192, v52
  v_mov_b32 v64, 0
  v_mov_b32 v65, 0
  v_mov_b32 v66, 0
  v_mov_b32 v67, 0
  s_waitcnt lgkmcnt(0)
  s_lshl_b32 s64, s69, 16
  s_and_b32 s65, s69, 0xffff0000
  s_bitcmp0_b32 s67, 0
  s_cselect_b32 s69, s64, s65
  s_lshl_b32 s64, s70, 16
  s_and_b32 s65, s70, 0xffff0000
  s_bitcmp0_b32 s67, 0
  s_cselect_b32 s70, s64, s65
  v_mov_b32 v68, 0x3fb8aa3b
  v_mul_f32 v68, s69, v68
  v_exp_f32 v68, v68
  s_nop 0
  v_cvt_pk_bf16_f32 v68, v68, v68
  v_lshlrev_b32 v68, 16, v68
  v_cmp_eq_u32 vcc, 0, v1
  v_mov_b32 v2, s70
  s_nop 0
  v_cndmask_b32 v69, 0, v2, vcc
  s_cmp_eq_u32 s68, 0
  s_cbranch_scc0 L_mix_kernel_B1
  v_bfe_u32 v200, v10, 1, 1
  v_add3_u32 v200, v200, v10, 0
  v_lshrrev_b32 v200, 1, v200
  v_lshrrev_b32 v3, 3, v200
  v_lshl_add_u32 v200, v200, 1, v3
  v_add_u32 v200, 32, v200
  v_and_b32 v2, 15, v200
  v_xor_b32 v2, v2, v11
  v_lshlrev_b32 v2, 4, v2
  v_lshl_add_u32 v2, v200, 9, v2
  v_add_u32 v56, s76, v2
  v_xor_b32 v57, 64, v56
  v_xor_b32 v58, 128, v56
  v_xor_b32 v59, 192, v56
  v_bfe_u32 v200, v10, 2, 1
  v_add3_u32 v200, v200, v10, 1
  v_lshrrev_b32 v200, 2, v200
  v_lshlrev_b32 v200, 1, v200
  v_add_u32 v200, 50, v200
  v_and_b32 v2, 15, v200
  v_xor_b32 v2, v2, v11
  v_lshlrev_b32 v2, 4, v2
  v_lshl_add_u32 v2, v200, 9, v2
  v_add_u32 v60, s76, v2
  v_xor_b32 v61, 64, v60
  v_xor_b32 v62, 128, v60
  v_xor_b32 v63, 192, v60
  s_waitcnt vmcnt(4)
  v_lshlrev_b32 v70, 16, v15
  v_and_b32 v71, 0xffff0000, v15
  v_mul_f32 v70, 0x3fb8aa3b, v70
  v_mul_f32 v71, 0x3fb8aa3b, v71
  v_exp_f32 v70, v70
  v_exp_f32 v71, v71
  s_waitcnt vmcnt(3)
  v_lshlrev_b32 v72, 16, v16
  v_and_b32 v73, 0xffff0000, v16
  v_cvt_pk_bf16_f32 v2, v70, v71
  v_mul_f32 v72, v72, v68
  v_mul_f32 v73, v73, v68
  v_lshlrev_b32 v70, 16, v2
  v_and_b32 v71, 0xffff0000, v2
  v_mul_f32 v72, 0x3e22f983, v72
  v_mul_f32 v73, 0x3e22f983, v73
  v_mul_f32 v70, v70, v68
  v_mul_f32 v71, v71, v68
  v_mul_f32 v70, 0xbfb8aa3b, v70
  v_mul_f32 v71, 0xbfb8aa3b, v71
  s_waitcnt vmcnt(2)
  v_lshlrev_b32 v74, 16, v17
  v_and_b32 v76, 0xffff0000, v17
  s_waitcnt vmcnt(1)
  v_lshlrev_b32 v75, 16, v18
  v_and_b32 v77, 0xffff0000, v18
  v_add_f32 v2, v68, v68
  v_mul_f32 v74, v74, v2
  v_mul_f32 v76, v76, v2
  v_mul_f32 v75, v75, v2
  v_mul_f32 v77, v77, v2
  v_mul_f32 v82, 0x41800000, v70
  v_mul_f32 v84, 0x41800000, v71
  v_mul_f32 v83, 0x41800000, v72
  v_mul_f32 v85, 0x41800000, v73
  v_exp_f32 v82, v82
  v_exp_f32 v84, v84
  v_fract_f32 v83, v83
  v_fract_f32 v85, v85
  v_cos_f32 v98, v83
  v_cos_f32 v100, v85
  v_sin_f32 v99, v83
  v_sin_f32 v101, v85
  v_pk_mul_f32 v[98:99], v[98:99], v[82:83] op_sel_hi:[1,0]
  v_pk_mul_f32 v[100:101], v[100:101], v[84:85] op_sel_hi:[1,0]
  v_mul_f32 v82, 0x43800000, v70
  v_mul_f32 v84, 0x43800000, v71
  v_mul_f32 v83, 0x43800000, v72
  v_mul_f32 v85, 0x43800000, v73
  v_exp_f32 v82, v82
  v_exp_f32 v84, v84
  v_fract_f32 v83, v83
  v_fract_f32 v85, v85
  v_cos_f32 v94, v83
  v_cos_f32 v96, v85
  v_sin_f32 v95, v83
  v_sin_f32 v97, v85
  v_pk_mul_f32 v[94:95], v[94:95], v[82:83] op_sel_hi:[1,0]
  v_pk_mul_f32 v[96:97], v[96:97], v[84:85] op_sel_hi:[1,0]
  v_pk_mul_f32 v[78:79], v[94:95], v[74:75] op_sel:[0,0] op_sel_hi:[0,1]
  v_pk_mul_f32 v[80:81], v[96:97], v[76:77] op_sel:[0,0] op_sel_hi:[0,1]
  v_pk_fma_f32 v[94:95], v[94:95], v[74:75], v[78:79] op_sel:[1,1,0] op_sel_hi:[1,0,1] neg_lo:[0,1,0]
  v_pk_fma_f32 v[96:97], v[96:97], v[76:77], v[80:81] op_sel:[1,1,0] op_sel_hi:[1,0,1] neg_lo:[0,1,0]
  v_cvt_pk_bf16_f32 v86, v74, -v75
  v_cvt_pk_bf16_f32 v87, v76, -v77
  ds_write_b64 v36, v[86:87] offset:0
  buffer_load_dwordx2 v[26:27], v34, s[40:43], 0 offen offset:0
  v_cvt_pk_bf16_f32 v88, v94, -v95
  v_cvt_pk_bf16_f32 v89, v96, -v97
  ds_write_b64 v36, v[88:89] offset:8192
  v_pk_mul_f32 v[78:79], v[74:75], v[98:99] op_sel:[0,0] op_sel_hi:[0,1]
  v_pk_mul_f32 v[80:81], v[76:77], v[100:101] op_sel:[0,0] op_sel_hi:[0,1]
  v_pk_fma_f32 v[90:91], v[74:75], v[98:99], v[78:79] op_sel:[1,1,0] op_sel_hi:[1,0,1] neg_lo:[0,1,0]
  v_pk_fma_f32 v[92:93], v[76:77], v[100:101], v[80:81] op_sel:[1,1,0] op_sel_hi:[1,0,1] neg_lo:[0,1,0]
  v_pk_mul_f32 v[82:83], v[94:95], v[98:99] op_sel:[0,0] op_sel_hi:[0,1]
  v_pk_mul_f32 v[84:85], v[96:97], v[100:101] op_sel:[0,0] op_sel_hi:[0,1]
  v_pk_fma_f32 v[94:95], v[94:95], v[98:99], v[82:83] op_sel:[1,1,0] op_sel_hi:[1,0,1] neg_lo:[0,1,0]
  v_pk_fma_f32 v[96:97], v[96:97], v[100:101], v[84:85] op_sel:[1,1,0] op_sel_hi:[1,0,1] neg_lo:[0,1,0]
  v_cvt_pk_bf16_f32 v86, v90, -v91
  v_cvt_pk_bf16_f32 v87, v92, -v93
  ds_write_b64 v37, v[86:87] offset:512
  v_cvt_pk_bf16_f32 v88, v94, -v95
  v_cvt_pk_bf16_f32 v89, v96, -v97
  ds_write_b64 v37, v[88:89] offset:8704
  v_pk_mul_f32 v[78:79], v[90:91], v[98:99] op_sel:[0,0] op_sel_hi:[0,1]
  v_pk_mul_f32 v[80:81], v[92:93], v[100:101] op_sel:[0,0] op_sel_hi:[0,1]
  v_pk_fma_f32 v[90:91], v[90:91], v[98:99], v[78:79] op_sel:[1,1,0] op_sel_hi:[1,0,1] neg_lo:[0,1,0]
  v_pk_fma_f32 v[92:93], v[92:93], v[100:101], v[80:81] op_sel:[1,1,0] op_sel_hi:[1,0,1] neg_lo:[0,1,0]
  v_pk_mul_f32 v[82:83], v[94:95], v[98:99] op_sel:[0,0] op_sel_hi:[0,1]
  v_pk_mul_f32 v[84:85], v[96:97], v[100:101] op_sel:[0,0] op_sel_hi:[0,1]
  v_pk_fma_f32 v[94:95], v[94:95], v[98:99], v[82:83] op_sel:[1,1,0] op_sel_hi:[1,0,1] neg_lo:[0,1,0]
  v_pk_fma_f32 v[96:97], v[96:97], v[100:101], v[84:85] op_sel:[1,1,0] op_sel_hi:[1,0,1] neg_lo:[0,1,0]
  v_cvt_pk_bf16_f32 v86, v90, -v91
  v_cvt_pk_bf16_f32 v87, v92, -v93
  ds_write_b64 v38, v[86:87] offset:1024
  v_cvt_pk_bf16_f32 v88, v94, -v95
  v_cvt_pk_bf16_f32 v89, v96, -v97
  ds_write_b64 v38, v[88:89] offset:9216
  v_pk_mul_f32 v[78:79], v[90:91], v[98:99] op_sel:[0,0] op_sel_hi:[0,1]
  v_pk_mul_f32 v[80:81], v[92:93], v[100:101] op_sel:[0,0] op_sel_hi:[0,1]
  v_pk_fma_f32 v[90:91], v[90:91], v[98:99], v[78:79] op_sel:[1,1,0] op_sel_hi:[1,0,1] neg_lo:[0,1,0]
  v_pk_fma_f32 v[92:93], v[92:93], v[100:101], v[80:81] op_sel:[1,1,0] op_sel_hi:[1,0,1] neg_lo:[0,1,0]
  v_pk_mul_f32 v[82:83], v[94:95], v[98:99] op_sel:[0,0] op_sel_hi:[0,1]
  v_pk_mul_f32 v[84:85], v[96:97], v[100:101] op_sel:[0,0] op_sel_hi:[0,1]
  v_pk_fma_f32 v[94:95], v[94:95], v[98:99], v[82:83] op_sel:[1,1,0] op_sel_hi:[1,0,1] neg_lo:[0,1,0]
  v_pk_fma_f32 v[96:97], v[96:97], v[100:101], v[84:85] op_sel:[1,1,0] op_sel_hi:[1,0,1] neg_lo:[0,1,0]
  v_cvt_pk_bf16_f32 v86, v90, -v91
  v_cvt_pk_bf16_f32 v87, v92, -v93
  ds_write_b64 v39, v[86:87] offset:1536
  v_cvt_pk_bf16_f32 v88, v94, -v95
  v_cvt_pk_bf16_f32 v89, v96, -v97
  ds_write_b64 v39, v[88:89] offset:9728
  v_pk_mul_f32 v[78:79], v[90:91], v[98:99] op_sel:[0,0] op_sel_hi:[0,1]
  v_pk_mul_f32 v[80:81], v[92:93], v[100:101] op_sel:[0,0] op_sel_hi:[0,1]
  v_pk_fma_f32 v[90:91], v[90:91], v[98:99], v[78:79] op_sel:[1,1,0] op_sel_hi:[1,0,1] neg_lo:[0,1,0]
  v_pk_fma_f32 v[92:93], v[92:93], v[100:101], v[80:81] op_sel:[1,1,0] op_sel_hi:[1,0,1] neg_lo:[0,1,0]
  v_pk_mul_f32 v[82:83], v[94:95], v[98:99] op_sel:[0,0] op_sel_hi:[0,1]
  v_pk_mul_f32 v[84:85], v[96:97], v[100:101] op_sel:[0,0] op_sel_hi:[0,1]
  v_pk_fma_f32 v[94:95], v[94:95], v[98:99], v[82:83] op_sel:[1,1,0] op_sel_hi:[1,0,1] neg_lo:[0,1,0]
  v_pk_fma_f32 v[96:97], v[96:97], v[100:101], v[84:85] op_sel:[1,1,0] op_sel_hi:[1,0,1] neg_lo:[0,1,0]
  v_cvt_pk_bf16_f32 v86, v90, -v91
  v_cvt_pk_bf16_f32 v87, v92, -v93
  ds_write_b64 v40, v[86:87] offset:2048
  v_cvt_pk_bf16_f32 v88, v94, -v95
  v_cvt_pk_bf16_f32 v89, v96, -v97
  ds_write_b64 v40, v[88:89] offset:10240
  v_pk_mul_f32 v[78:79], v[90:91], v[98:99] op_sel:[0,0] op_sel_hi:[0,1]
  v_pk_mul_f32 v[80:81], v[92:93], v[100:101] op_sel:[0,0] op_sel_hi:[0,1]
  v_pk_fma_f32 v[90:91], v[90:91], v[98:99], v[78:79] op_sel:[1,1,0] op_sel_hi:[1,0,1] neg_lo:[0,1,0]
  v_pk_fma_f32 v[92:93], v[92:93], v[100:101], v[80:81] op_sel:[1,1,0] op_sel_hi:[1,0,1] neg_lo:[0,1,0]
  v_pk_mul_f32 v[82:83], v[94:95], v[98:99] op_sel:[0,0] op_sel_hi:[0,1]
  v_pk_mul_f32 v[84:85], v[96:97], v[100:101] op_sel:[0,0] op_sel_hi:[0,1]
  v_pk_fma_f32 v[94:95], v[94:95], v[98:99], v[82:83] op_sel:[1,1,0] op_sel_hi:[1,0,1] neg_lo:[0,1,0]
  v_pk_fma_f32 v[96:97], v[96:97], v[100:101], v[84:85] op_sel:[1,1,0] op_sel_hi:[1,0,1] neg_lo:[0,1,0]
  v_cvt_pk_bf16_f32 v86, v90, -v91
  v_cvt_pk_bf16_f32 v87, v92, -v93
  ds_write_b64 v41, v[86:87] offset:2560
  buffer_load_dwordx2 v[28:29], v34, s[40:43], 0 offen offset:1024
  v_cvt_pk_bf16_f32 v88, v94, -v95
  v_cvt_pk_bf16_f32 v89, v96, -v97
  ds_write_b64 v41, v[88:89] offset:10752
  v_pk_mul_f32 v[78:79], v[90:91], v[98:99] op_sel:[0,0] op_sel_hi:[0,1]
  v_pk_mul_f32 v[80:81], v[92:93], v[100:101] op_sel:[0,0] op_sel_hi:[0,1]
  v_pk_fma_f32 v[90:91], v[90:91], v[98:99], v[78:79] op_sel:[1,1,0] op_sel_hi:[1,0,1] neg_lo:[0,1,0]
  v_pk_fma_f32 v[92:93], v[92:93], v[100:101], v[80:81] op_sel:[1,1,0] op_sel_hi:[1,0,1] neg_lo:[0,1,0]
  v_pk_mul_f32 v[82:83], v[94:95], v[98:99] op_sel:[0,0] op_sel_hi:[0,1]
  v_pk_mul_f32 v[84:85], v[96:97], v[100:101] op_sel:[0,0] op_sel_hi:[0,1]
  v_pk_fma_f32 v[94:95], v[94:95], v[98:99], v[82:83] op_sel:[1,1,0] op_sel_hi:[1,0,1] neg_lo:[0,1,0]
  v_pk_fma_f32 v[96:97], v[96:97], v[100:101], v[84:85] op_sel:[1,1,0] op_sel_hi:[1,0,1] neg_lo:[0,1,0]
  v_cvt_pk_bf16_f32 v86, v90, -v91
  v_cvt_pk_bf16_f32 v87, v92, -v93
  ds_write_b64 v42, v[86:87] offset:3072
  v_cvt_pk_bf16_f32 v88, v94, -v95
  v_cvt_pk_bf16_f32 v89, v96, -v97
  ds_write_b64 v42, v[88:89] offset:11264
  v_pk_mul_f32 v[78:79], v[90:91], v[98:99] op_sel:[0,0] op_sel_hi:[0,1]
  v_pk_mul_f32 v[80:81], v[92:93], v[100:101] op_sel:[0,0] op_sel_hi:[0,1]
  v_pk_fma_f32 v[90:91], v[90:91], v[98:99], v[78:79] op_sel:[1,1,0] op_sel_hi:[1,0,1] neg_lo:[0,1,0]
  v_pk_fma_f32 v[92:93], v[92:93], v[100:101], v[80:81] op_sel:[1,1,0] op_sel_hi:[1,0,1] neg_lo:[0,1,0]
  v_pk_mul_f32 v[82:83], v[94:95], v[98:99] op_sel:[0,0] op_sel_hi:[0,1]
  v_pk_mul_f32 v[84:85], v[96:97], v[100:101] op_sel:[0,0] op_sel_hi:[0,1]
  v_pk_fma_f32 v[94:95], v[94:95], v[98:99], v[82:83] op_sel:[1,1,0] op_sel_hi:[1,0,1] neg_lo:[0,1,0]
  v_pk_fma_f32 v[96:97], v[96:97], v[100:101], v[84:85] op_sel:[1,1,0] op_sel_hi:[1,0,1] neg_lo:[0,1,0]
  v_cvt_pk_bf16_f32 v86, v90, -v91
  v_cvt_pk_bf16_f32 v87, v92, -v93
  ds_write_b64 v43, v[86:87] offset:3584
  v_cvt_pk_bf16_f32 v88, v94, -v95
  v_cvt_pk_bf16_f32 v89, v96, -v97
  s_waitcnt lgkmcnt(14)
  ds_write_b64 v43, v[88:89] offset:11776
  v_pk_mul_f32 v[78:79], v[90:91], v[98:99] op_sel:[0,0] op_sel_hi:[0,1]
  v_pk_mul_f32 v[80:81], v[92:93], v[100:101] op_sel:[0,0] op_sel_hi:[0,1]
  v_pk_fma_f32 v[90:91], v[90:91], v[98:99], v[78:79] op_sel:[1,1,0] op_sel_hi:[1,0,1] neg_lo:[0,1,0]
  v_pk_fma_f32 v[92:93], v[92:93], v[100:101], v[80:81] op_sel:[1,1,0] op_sel_hi:[1,0,1] neg_lo:[0,1,0]
  v_pk_mul_f32 v[82:83], v[94:95], v[98:99] op_sel:[0,0] op_sel_hi:[0,1]
  v_pk_mul_f32 v[84:85], v[96:97], v[100:101] op_sel:[0,0] op_sel_hi:[0,1]
  v_pk_fma_f32 v[94:95], v[94:95], v[98:99], v[82:83] op_sel:[1,1,0] op_sel_hi:[1,0,1] neg_lo:[0,1,0]
  v_pk_fma_f32 v[96:97], v[96:97], v[100:101], v[84:85] op_sel:[1,1,0] op_sel_hi:[1,0,1] neg_lo:[0,1,0]
  v_cvt_pk_bf16_f32 v86, v90, -v91
  v_cvt_pk_bf16_f32 v87, v92, -v93
  s_waitcnt lgkmcnt(14)
  ds_write_b64 v44, v[86:87] offset:4096
  v_cvt_pk_bf16_f32 v88, v94, -v95
  v_cvt_pk_bf16_f32 v89, v96, -v97
  s_waitcnt lgkmcnt(14)
  ds_write_b64 v44, v[88:89] offset:12288
  v_pk_mul_f32 v[78:79], v[90:91], v[98:99] op_sel:[0,0] op_sel_hi:[0,1]
  v_pk_mul_f32 v[80:81], v[92:93], v[100:101] op_sel:[0,0] op_sel_hi:[0,1]
  v_pk_fma_f32 v[90:91], v[90:91], v[98:99], v[78:79] op_sel:[1,1,0] op_sel_hi:[1,0,1] neg_lo:[0,1,0]
  v_pk_fma_f32 v[92:93], v[92:93], v[100:101], v[80:81] op_sel:[1,1,0] op_sel_hi:[1,0,1] neg_lo:[0,1,0]
  v_pk_mul_f32 v[82:83], v[94:95], v[98:99] op_sel:[0,0] op_sel_hi:[0,1]
  v_pk_mul_f32 v[84:85], v[96:97], v[100:101] op_sel:[0,0] op_sel_hi:[0,1]
  v_pk_fma_f32 v[94:95], v[94:95], v[98:99], v[82:83] op_sel:[1,1,0] op_sel_hi:[1,0,1] neg_lo:[0,1,0]
  v_pk_fma_f32 v[96:97], v[96:97], v[100:101], v[84:85] op_sel:[1,1,0] op_sel_hi:[1,0,1] neg_lo:[0,1,0]
  v_cvt_pk_bf16_f32 v86, v90, -v91
  v_cvt_pk_bf16_f32 v87, v92, -v93
  s_waitcnt lgkmcnt(14)
  ds_write_b64 v45, v[86:87] offset:4608
  v_cvt_pk_bf16_f32 v88, v94, -v95
  v_cvt_pk_bf16_f32 v89, v96, -v97
  s_waitcnt lgkmcnt(14)
  ds_write_b64 v45, v[88:89] offset:12800
  v_pk_mul_f32 v[78:79], v[90:91], v[98:99] op_sel:[0,0] op_sel_hi:[0,1]
  v_pk_mul_f32 v[80:81], v[92:93], v[100:101] op_sel:[0,0] op_sel_hi:[0,1]
  v_pk_fma_f32 v[90:91], v[90:91], v[98:99], v[78:79] op_sel:[1,1,0] op_sel_hi:[1,0,1] neg_lo:[0,1,0]
  v_pk_fma_f32 v[92:93], v[92:93], v[100:101], v[80:81] op_sel:[1,1,0] op_sel_hi:[1,0,1] neg_lo:[0,1,0]
  v_pk_mul_f32 v[82:83], v[94:95], v[98:99] op_sel:[0,0] op_sel_hi:[0,1]
  v_pk_mul_f32 v[84:85], v[96:97], v[100:101] op_sel:[0,0] op_sel_hi:[0,1]
  v_pk_fma_f32 v[94:95], v[94:95], v[98:99], v[82:83] op_sel:[1,1,0] op_sel_hi:[1,0,1] neg_lo:[0,1,0]
  v_pk_fma_f32 v[96:97], v[96:97], v[100:101], v[84:85] op_sel:[1,1,0] op_sel_hi:[1,0,1] neg_lo:[0,1,0]
  v_cvt_pk_bf16_f32 v86, v90, -v91
  v_cvt_pk_bf16_f32 v87, v92, -v93
  s_waitcnt lgkmcnt(14)
  ds_write_b64 v46, v[86:87] offset:5120
  buffer_load_dwordx2 v[30:31], v34, s[40:43], 0 offen offset:2048
  v_cvt_pk_bf16_f32 v88, v94, -v95
  v_cvt_pk_bf16_f32 v89, v96, -v97
  s_waitcnt lgkmcnt(14)
  ds_write_b64 v46, v[88:89] offset:13312
  v_pk_mul_f32 v[78:79], v[90:91], v[98:99] op_sel:[0,0] op_sel_hi:[0,1]
  v_pk_mul_f32 v[80:81], v[92:93], v[100:101] op_sel:[0,0] op_sel_hi:[0,1]
  v_pk_fma_f32 v[90:91], v[90:91], v[98:99], v[78:79] op_sel:[1,1,0] op_sel_hi:[1,0,1] neg_lo:[0,1,0]
  v_pk_fma_f32 v[92:93], v[92:93], v[100:101], v[80:81] op_sel:[1,1,0] op_sel_hi:[1,0,1] neg_lo:[0,1,0]
  v_pk_mul_f32 v[82:83], v[94:95], v[98:99] op_sel:[0,0] op_sel_hi:[0,1]
  v_pk_mul_f32 v[84:85], v[96:97], v[100:101] op_sel:[0,0] op_sel_hi:[0,1]
  v_pk_fma_f32 v[94:95], v[94:95], v[98:99], v[82:83] op_sel:[1,1,0] op_sel_hi:[1,0,1] neg_lo:[0,1,0]
  v_pk_fma_f32 v[96:97], v[96:97], v[100:101], v[84:85] op_sel:[1,1,0] op_sel_hi:[1,0,1] neg_lo:[0,1,0]
  v_cvt_pk_bf16_f32 v86, v90, -v91
  v_cvt_pk_bf16_f32 v87, v92, -v93
  s_waitcnt lgkmcnt(14)
  ds_write_b64 v47, v[86:87] offset:5632
  v_cvt_pk_bf16_f32 v88, v94, -v95
  v_cvt_pk_bf16_f32 v89, v96, -v97
  s_waitcnt lgkmcnt(14)
  ds_write_b64 v47, v[88:89] offset:13824
  v_pk_mul_f32 v[78:79], v[90:91], v[98:99] op_sel:[0,0] op_sel_hi:[0,1]
  v_pk_mul_f32 v[80:81], v[92:93], v[100:101] op_sel:[0,0] op_sel_hi:[0,1]
  v_pk_fma_f32 v[90:91], v[90:91], v[98:99], v[78:79] op_sel:[1,1,0] op_sel_hi:[1,0,1] neg_lo:[0,1,0]
  v_pk_fma_f32 v[92:93], v[92:93], v[100:101], v[80:81] op_sel:[1,1,0] op_sel_hi:[1,0,1] neg_lo:[0,1,0]
  v_pk_mul_f32 v[82:83], v[94:95], v[98:99] op_sel:[0,0] op_sel_hi:[0,1]
  v_pk_mul_f32 v[84:85], v[96:97], v[100:101] op_sel:[0,0] op_sel_hi:[0,1]
  v_pk_fma_f32 v[94:95], v[94:95], v[98:99], v[82:83] op_sel:[1,1,0] op_sel_hi:[1,0,1] neg_lo:[0,1,0]
  v_pk_fma_f32 v[96:97], v[96:97], v[100:101], v[84:85] op_sel:[1,1,0] op_sel_hi:[1,0,1] neg_lo:[0,1,0]
  v_cvt_pk_bf16_f32 v86, v90, -v91
  v_cvt_pk_bf16_f32 v87, v92, -v93
  s_waitcnt lgkmcnt(14)
  ds_write_b64 v48, v[86:87] offset:6144
  v_cvt_pk_bf16_f32 v88, v94, -v95
  v_cvt_pk_bf16_f32 v89, v96, -v97
  s_waitcnt lgkmcnt(14)
  ds_write_b64 v48, v[88:89] offset:14336
  v_pk_mul_f32 v[78:79], v[90:91], v[98:99] op_sel:[0,0] op_sel_hi:[0,1]
  v_pk_mul_f32 v[80:81], v[92:93], v[100:101] op_sel:[0,0] op_sel_hi:[0,1]
  v_pk_fma_f32 v[90:91], v[90:91], v[98:99], v[78:79] op_sel:[1,1,0] op_sel_hi:[1,0,1] neg_lo:[0,1,0]
  v_pk_fma_f32 v[92:93], v[92:93], v[100:101], v[80:81] op_sel:[1,1,0] op_sel_hi:[1,0,1] neg_lo:[0,1,0]
  v_pk_mul_f32 v[82:83], v[94:95], v[98:99] op_sel:[0,0] op_sel_hi:[0,1]
  v_pk_mul_f32 v[84:85], v[96:97], v[100:101] op_sel:[0,0] op_sel_hi:[0,1]
  v_pk_fma_f32 v[94:95], v[94:95], v[98:99], v[82:83] op_sel:[1,1,0] op_sel_hi:[1,0,1] neg_lo:[0,1,0]
  v_pk_fma_f32 v[96:97], v[96:97], v[100:101], v[84:85] op_sel:[1,1,0] op_sel_hi:[1,0,1] neg_lo:[0,1,0]
  v_cvt_pk_bf16_f32 v86, v90, -v91
  v_cvt_pk_bf16_f32 v87, v92, -v93
  s_waitcnt lgkmcnt(14)
  ds_write_b64 v49, v[86:87] offset:6656
  v_cvt_pk_bf16_f32 v88, v94, -v95
  v_cvt_pk_bf16_f32 v89, v96, -v97
  s_waitcnt lgkmcnt(14)
  ds_write_b64 v49, v[88:89] offset:14848
  v_pk_mul_f32 v[78:79], v[90:91], v[98:99] op_sel:[0,0] op_sel_hi:[0,1]
  v_pk_mul_f32 v[80:81], v[92:93], v[100:101] op_sel:[0,0] op_sel_hi:[0,1]
  v_pk_fma_f32 v[90:91], v[90:91], v[98:99], v[78:79] op_sel:[1,1,0] op_sel_hi:[1,0,1] neg_lo:[0,1,0]
  v_pk_fma_f32 v[92:93], v[92:93], v[100:101], v[80:81] op_sel:[1,1,0] op_sel_hi:[1,0,1] neg_lo:[0,1,0]
  v_pk_mul_f32 v[82:83], v[94:95], v[98:99] op_sel:[0,0] op_sel_hi:[0,1]
  v_pk_mul_f32 v[84:85], v[96:97], v[100:101] op_sel:[0,0] op_sel_hi:[0,1]
  v_pk_fma_f32 v[94:95], v[94:95], v[98:99], v[82:83] op_sel:[1,1,0] op_sel_hi:[1,0,1] neg_lo:[0,1,0]
  v_pk_fma_f32 v[96:97], v[96:97], v[100:101], v[84:85] op_sel:[1,1,0] op_sel_hi:[1,0,1] neg_lo:[0,1,0]
  v_cvt_pk_bf16_f32 v86, v90, -v91
  v_cvt_pk_bf16_f32 v87, v92, -v93
  s_waitcnt lgkmcnt(14)
  ds_write_b64 v50, v[86:87] offset:7168
  v_cvt_pk_bf16_f32 v88, v94, -v95
  v_cvt_pk_bf16_f32 v89, v96, -v97
  s_waitcnt lgkmcnt(14)
  ds_write_b64 v50, v[88:89] offset:15360
  v_pk_mul_f32 v[78:79], v[90:91], v[98:99] op_sel:[0,0] op_sel_hi:[0,1]
  v_pk_mul_f32 v[80:81], v[92:93], v[100:101] op_sel:[0,0] op_sel_hi:[0,1]
  v_pk_fma_f32 v[90:91], v[90:91], v[98:99], v[78:79] op_sel:[1,1,0] op_sel_hi:[1,0,1] neg_lo:[0,1,0]
  v_pk_fma_f32 v[92:93], v[92:93], v[100:101], v[80:81] op_sel:[1,1,0] op_sel_hi:[1,0,1] neg_lo:[0,1,0]
  v_pk_mul_f32 v[82:83], v[94:95], v[98:99] op_sel:[0,0] op_sel_hi:[0,1]
  v_pk_mul_f32 v[84:85], v[96:97], v[100:101] op_sel:[0,0] op_sel_hi:[0,1]
  v_pk_fma_f32 v[94:95], v[94:95], v[98:99], v[82:83] op_sel:[1,1,0] op_sel_hi:[1,0,1] neg_lo:[0,1,0]
  v_pk_fma_f32 v[96:97], v[96:97], v[100:101], v[84:85] op_sel:[1,1,0] op_sel_hi:[1,0,1] neg_lo:[0,1,0]
  v_cvt_pk_bf16_f32 v86, v90, -v91
  v_cvt_pk_bf16_f32 v87, v92, -v93
  s_waitcnt lgkmcnt(14)
  ds_write_b64 v51, v[86:87] offset:7680
  v_cvt_pk_bf16_f32 v88, v94, -v95
  v_cvt_pk_bf16_f32 v89, v96, -v97
  s_waitcnt lgkmcnt(14)
  ds_write_b64 v51, v[88:89] offset:15872
  s_waitcnt lgkmcnt(0)
  s_barrier
  ds_read_b128 v[140:143], v52 offset:0
  ds_read_b128 v[148:151], v52 offset:16384
  ds_read_b128 v[144:147], v52 offset:8192
  ds_read_b128 v[152:155], v56 offset:0
  ds_read_b128 v[156:159], v60 offset:0
  ds_read_b128 v[160:163], v53 offset:0
  buffer_load_dwordx2 v[32:33], v34, s[40:43], 0 offen offset:3072
  ds_read_b128 v[168:171], v53 offset:16384
  ds_read_b128 v[164:167], v53 offset:8192
  ds_read_b128 v[172:175], v57 offset:0
  ds_read_b128 v[176:179], v61 offset:0
  ds_read_b128 v[180:183], v54 offset:0
  ds_read_b128 v[188:191], v54 offset:16384
  s_mov_b64 exec, 1
  buffer_load_dwordx2 v[20:21], v35, s[40:43], 0 offen offset:0
  buffer_load_dwordx2 v[22:23], v35, s[40:43], 0 offen offset:1024
  buffer_load_dwordx2 v[24:25], v35, s[40:43], 0 offen offset:2048
  s_mov_b64 exec, -1
  ds_read_b128 v[184:187], v54 offset:8192
  ds_read_b128 v[192:195], v58 offset:0
  ds_read_b128 v[196:199], v62 offset:0
  s_waitcnt lgkmcnt(13)
  v_mfma_f32_16x16x32_bf16 v[124:127], v[148:151], v[140:143], 0
  s_waitcnt lgkmcnt(11)
  v_mfma_f32_16x16x32_bf16 v[128:131], v[152:155], v[144:147], 0
  s_waitcnt lgkmcnt(10)
  v_mfma_f32_16x16x32_bf16 v[132:135], v[156:159], v[140:143], 0
  v_mfma_f32_16x16x32_bf16 v[136:139], v[156:159], v[144:147], 0
  ds_read_b128 v[140:143], v55 offset:0
  ds_read_b128 v[148:151], v55 offset:16384
  ds_read_b128 v[144:147], v55 offset:8192
  ds_read_b128 v[152:155], v59 offset:0
  ds_read_b128 v[156:159], v63 offset:0
  s_waitcnt lgkmcnt(13)
  v_mfma_f32_16x16x32_bf16 v[124:127], v[168:171], v[160:163], v[124:127]
  s_waitcnt lgkmcnt(11)
  v_mfma_f32_16x16x32_bf16 v[128:131], v[172:175], v[164:167], v[128:131]
  s_waitcnt lgkmcnt(10)
  v_mfma_f32_16x16x32_bf16 v[132:135], v[176:179], v[160:163], v[132:135]
  v_mfma_f32_16x16x32_bf16 v[136:139], v[176:179], v[164:167], v[136:139]
  ds_read_b128 v[160:163], v52 offset:256
  ds_read_b128 v[168:171], v52 offset:16640
  ds_read_b128 v[164:167], v52 offset:8448
  ds_read_b128 v[172:175], v56 offset:256
  ds_read_b128 v[176:179], v60 offset:256
  s_waitcnt lgkmcnt(13)
  v_mfma_f32_16x16x32_bf16 v[124:127], v[188:191], v[180:183], v[124:127]
  s_waitcnt lgkmcnt(11)
  v_mfma_f32_16x16x32_bf16 v[128:131], v[192:195], v[184:187], v[128:131]
  s_waitcnt lgkmcnt(10)
  v_mfma_f32_16x16x32_bf16 v[132:135], v[196:199], v[180:183], v[132:135]
  v_mfma_f32_16x16x32_bf16 v[136:139], v[196:199], v[184:187], v[136:139]
  ds_read_b128 v[180:183], v53 offset:256
  ds_read_b128 v[188:191], v53 offset:16640
  ds_read_b128 v[184:187], v53 offset:8448
  ds_read_b128 v[192:195], v57 offset:256
  ds_read_b128 v[196:199], v61 offset:256
  s_waitcnt lgkmcnt(13)
  v_mfma_f32_16x16x32_bf16 v[124:127], v[148:151], v[140:143], v[124:127]
  s_waitcnt lgkmcnt(11)
  v_mfma_f32_16x16x32_bf16 v[128:131], v[152:155], v[144:147], v[128:131]
  s_waitcnt lgkmcnt(10)
  v_mfma_f32_16x16x32_bf16 v[132:135], v[156:159], v[140:143], v[132:135]
  v_mfma_f32_16x16x32_bf16 v[136:139], v[156:159], v[144:147], v[136:139]
  ds_read_b128 v[140:143], v54 offset:256
  ds_read_b128 v[148:151], v54 offset:16640
  ds_read_b128 v[144:147], v54 offset:8448
  ds_read_b128 v[152:155], v58 offset:256
  ds_read_b128 v[156:159], v62 offset:256
  s_waitcnt lgkmcnt(13)
  v_mfma_f32_16x16x32_bf16 v[124:127], v[168:171], v[160:163], v[124:127]
  s_waitcnt lgkmcnt(11)
  v_mfma_f32_16x16x32_bf16 v[128:131], v[172:175], v[164:167], v[128:131]
  s_waitcnt lgkmcnt(10)
  v_mfma_f32_16x16x32_bf16 v[132:135], v[176:179], v[160:163], v[132:135]
  v_mfma_f32_16x16x32_bf16 v[136:139], v[176:179], v[164:167], v[136:139]
  ds_read_b128 v[160:163], v55 offset:256
  ds_read_b128 v[168:171], v55 offset:16640
  ds_read_b128 v[164:167], v55 offset:8448
  ds_read_b128 v[172:175], v59 offset:256
  ds_read_b128 v[176:179], v63 offset:256
  s_waitcnt lgkmcnt(13)
  v_mfma_f32_16x16x32_bf16 v[124:127], v[188:191], v[180:183], v[124:127]
  s_waitcnt lgkmcnt(11)
  v_mfma_f32_16x16x32_bf16 v[128:131], v[192:195], v[184:187], v[128:131]
  s_waitcnt lgkmcnt(10)
  v_mfma_f32_16x16x32_bf16 v[132:135], v[196:199], v[180:183], v[132:135]
  v_mfma_f32_16x16x32_bf16 v[136:139], v[196:199], v[184:187], v[136:139]
  s_waitcnt lgkmcnt(8)
  v_mfma_f32_16x16x32_bf16 v[124:127], v[148:151], v[140:143], v[124:127]
  s_waitcnt lgkmcnt(6)
  v_mfma_f32_16x16x32_bf16 v[128:131], v[152:155], v[144:147], v[128:131]
  s_waitcnt lgkmcnt(5)
  v_mfma_f32_16x16x32_bf16 v[132:135], v[156:159], v[140:143], v[132:135]
  v_mfma_f32_16x16x32_bf16 v[136:139], v[156:159], v[144:147], v[136:139]
  s_waitcnt lgkmcnt(3)
  v_mfma_f32_16x16x32_bf16 v[124:127], v[168:171], v[160:163], v[124:127]
  s_waitcnt lgkmcnt(1)
  v_mfma_f32_16x16x32_bf16 v[128:131], v[172:175], v[164:167], v[128:131]
  s_waitcnt lgkmcnt(0)
  v_mfma_f32_16x16x32_bf16 v[132:135], v[176:179], v[160:163], v[132:135]
  v_mfma_f32_16x16x32_bf16 v[136:139], v[176:179], v[164:167], v[136:139]
  s_waitcnt vmcnt(2)
  v_mov_b32_dpp v20, v28 wave_shr:1 row_mask:0xf bank_mask:0xf
  v_mov_b32_dpp v21, v29 wave_shr:1 row_mask:0xf bank_mask:0xf
  s_waitcnt vmcnt(1)
  v_mov_b32_dpp v22, v30 wave_shr:1 row_mask:0xf bank_mask:0xf
  v_mov_b32_dpp v23, v31 wave_shr:1 row_mask:0xf bank_mask:0xf
  s_waitcnt vmcnt(0)
  v_mov_b32_dpp v24, v32 wave_shr:1 row_mask:0xf bank_mask:0xf
  v_mov_b32_dpp v25, v33 wave_shr:1 row_mask:0xf bank_mask:0xf
  s_mov_b32 s72, 0x05040100
  s_mov_b32 s73, 0x07060302
  v_lshrrev_b32 v2, 4, v1
  v_mul_u32_u24 v2, 31744, v2
  v_bfe_u32 v3, v1, 2, 2
  v_mul_u32_u24 v3, 4160, v3
  v_add_u32 v2, v2, v3
  v_and_b32 v3, 3, v1
  v_lshl_add_u32 v201, v3, 4, v2
  v_sub_u32 v202, 511, v0
  v_lshlrev_b32 v202, 3, v202
  v_add_u32 v203, 63488, v202
  v_perm_b32 v204, v24, v26, s72
  v_perm_b32 v205, v20, v22, s72
  v_perm_b32 v206, v26, v28, s72
  v_perm_b32 v207, v22, v24, s72
  v_perm_b32 v208, v28, v30, s72
  v_perm_b32 v209, v24, v26, s72
  v_perm_b32 v210, v30, v32, s72
  v_perm_b32 v211, v26, v28, s72
  v_perm_b32 v212, v24, v26, s73
  v_perm_b32 v213, v20, v22, s73
  v_perm_b32 v214, v26, v28, s73
  v_perm_b32 v215, v22, v24, s73
  v_perm_b32 v216, v28, v30, s73
  v_perm_b32 v217, v24, v26, s73
  v_perm_b32 v218, v30, v32, s73
  v_perm_b32 v219, v26, v28, s73
  v_perm_b32 v220, v25, v27, s72
  v_perm_b32 v221, v21, v23, s72
  v_perm_b32 v222, v27, v29, s72
  v_perm_b32 v223, v23, v25, s72
  v_perm_b32 v224, v29, v31, s72
  v_perm_b32 v225, v25, v27, s72
  v_perm_b32 v226, v31, v33, s72
  v_perm_b32 v227, v27, v29, s72
  v_perm_b32 v228, v25, v27, s73
  v_perm_b32 v229, v21, v23, s73
  v_perm_b32 v230, v27, v29, s73
  v_perm_b32 v231, v23, v25, s73
  v_perm_b32 v232, v29, v31, s73
  v_perm_b32 v233, v25, v27, s73
  v_perm_b32 v234, v31, v33, s73
  v_perm_b32 v235, v27, v29, s73
  s_add_u32 s76, s71, 16640
  v_lshlrev_b32 v4, 5, v1
  v_add_u32 v4, s76, v4
  v_add_f32 v124, v124, v69
  v_lshlrev_b32 v244, 3, v1
  v_add_u32 v244, s76, v244
  v_cvt_pk_bf16_f32 v236, v124, v125
  v_cvt_pk_bf16_f32 v237, v126, v127
  v_cvt_pk_bf16_f32 v238, v128, v129
  v_cvt_pk_bf16_f32 v239, v130, v131
  v_cvt_pk_bf16_f32 v240, v132, v133
  v_cvt_pk_bf16_f32 v241, v134, v135
  v_cvt_pk_bf16_f32 v242, v136, v137
  v_cvt_pk_bf16_f32 v243, v138, v139
  v_permlane32_swap_b32 v236, v240
  v_permlane32_swap_b32 v237, v241
  v_permlane32_swap_b32 v238, v242
  v_permlane32_swap_b32 v239, v243
  s_nop 0
  v_permlane16_swap_b32 v236, v238
  v_permlane16_swap_b32 v237, v239
  v_permlane16_swap_b32 v240, v242
  v_permlane16_swap_b32 v241, v243
  s_barrier
  ds_write_b64 v244, v[64:65]
  ds_write_b128 v4, v[236:239] offset:464
  ds_write_b128 v4, v[240:243] offset:480
  ds_write_b128 v201, v[64:67] offset:4096
  ds_write_b64 v202, v[204:205] offset:0
  ds_write_b64 v202, v[206:207] offset:4160
  ds_write_b64 v202, v[208:209] offset:8320
  ds_write_b64 v202, v[210:211] offset:12480
  ds_write_b64 v202, v[212:213] offset:31744
  ds_write_b64 v202, v[214:215] offset:35904
  ds_write_b64 v202, v[216:217] offset:40064
  ds_write_b64 v202, v[218:219] offset:44224
  ds_write_b64 v203, v[220:221] offset:0
  ds_write_b64 v203, v[222:223] offset:4160
  ds_write_b64 v203, v[224:225] offset:8320
  s_waitcnt lgkmcnt(14)
  ds_write_b64 v203, v[226:227] offset:12480
  s_waitcnt lgkmcnt(14)
  ds_write_b64 v203, v[228:229] offset:31744
  s_waitcnt lgkmcnt(14)
  ds_write_b64 v203, v[230:231] offset:35904
  s_waitcnt lgkmcnt(14)
  ds_write_b64 v203, v[232:233] offset:40064
  s_waitcnt lgkmcnt(14)
  ds_write_b64 v203, v[234:235] offset:44224
  v_and_b32 v2, 3, v10
  v_mul_u32_u24 v12, 4160, v2
  v_lshrrev_b32 v2, 2, v10
  v_sub_u32 v2, v11, v2
  v_add_u32 v2, 3, v2
  v_lshl_add_u32 v12, v2, 4, v12
  v_add_u32 v12, s71, v12
  v_lshrrev_b32 v2, 1, v10
  v_lshlrev_b32 v13, 6, v2
  v_lshl_add_u32 v13, v11, 4, v13
  v_and_b32 v2, 1, v10
  v_lshl_add_u32 v13, v2, 3, v13
  v_add3_u32 v13, v13, 8, s76
  s_waitcnt lgkmcnt(0)
  s_barrier
  ds_read_b128 v[48:51], v12 offset:3584
  ds_read_b64 v[80:81], v13 offset:0
  ds_read_b64 v[82:83], v13 offset:8
  ds_read_b128 v[52:55], v12 offset:3072
  ds_read_b64 v[84:85], v13 offset:512
  ds_read_b64 v[86:87], v13 offset:520
  ds_read_b128 v[56:59], v12 offset:2560
  ds_read_b64 v[88:89], v13 offset:1024
  ds_read_b64 v[90:91], v13 offset:1032
  ds_read_b128 v[60:63], v12 offset:2048
  ds_read_b64 v[92:93], v13 offset:1536
  ds_read_b64 v[94:95], v13 offset:1544
  ds_read_b128 v[64:67], v12 offset:1536
  ds_read_b64 v[96:97], v13 offset:2048
  ds_read_b64 v[98:99], v13 offset:2056
  s_waitcnt lgkmcnt(14)
  ds_read_b128 v[68:71], v12 offset:1024
  s_waitcnt lgkmcnt(14)
  ds_read_b64 v[100:101], v13 offset:2560
  s_waitcnt lgkmcnt(14)
  ds_read_b64 v[102:103], v13 offset:2568
  s_waitcnt lgkmcnt(14)
  ds_read_b128 v[72:75], v12 offset:512
  s_waitcnt lgkmcnt(14)
  ds_read_b64 v[104:105], v13 offset:3072
  s_waitcnt lgkmcnt(14)
  ds_read_b64 v[106:107], v13 offset:3080
  s_waitcnt lgkmcnt(14)
  ds_read_b128 v[76:79], v12 offset:0
  s_waitcnt lgkmcnt(14)
  ds_read_b64 v[108:109], v13 offset:3584
  s_waitcnt lgkmcnt(14)
  ds_read_b64 v[110:111], v13 offset:3592
  s_lshl_b32 s78, s35, 4
  s_add_u32 s78, s78, s36
  s_lshl_b32 s78, s78, 2
  s_add_u32 s78, s78, s82
  s_mov_b32 s60, s10
  s_and_b32 s61, s11, 0xffff
  s_mov_b32 s62, 524288
  s_mov_b32 s63, 0x20000
  v_lshrrev_b32 v2, 2, v1
  v_and_b32 v3, 3, v1
  v_lshlrev_b32 v3, 4, v3
  v_lshl_add_u32 v2, v2, 10, v3
  s_and_b32 s64, s78, 31
  s_lshl_b32 s64, s64, 14
  s_lshr_b32 s39, s78, 5
  s_lshl_b32 s39, s39, 6
  s_add_u32 s39, s64, s39
  s_lshl_b32 s64, s82, 10
  s_add_u32 m0, s64, 159744
  s_nop 0
  buffer_load_dwordx4 v2, s[60:63], s39 offen lds
  v_mfma_f32_16x16x32_bf16 v[16:19], v[48:51], v[80:83], 0
  v_mfma_f32_16x16x32_bf16 v[20:23], v[52:55], v[80:83], 0
  s_waitcnt lgkmcnt(14)
  ds_read_b128 v[112:115], v12 offset:3648
  v_mfma_f32_16x16x32_bf16 v[20:23], v[48:51], v[84:87], v[20:23]
  v_mfma_f32_16x16x32_bf16 v[24:27], v[52:55], v[84:87], 0
  s_waitcnt lgkmcnt(14)
  ds_read_b64 v[144:145], v13 offset:64
  v_mfma_f32_16x16x32_bf16 v[24:27], v[56:59], v[80:83], v[24:27]
  s_waitcnt lgkmcnt(14)
  ds_read_b64 v[146:147], v13 offset:72
  v_mfma_f32_16x16x32_bf16 v[28:31], v[56:59], v[84:87], 0
  v_mfma_f32_16x16x32_bf16 v[24:27], v[48:51], v[88:91], v[24:27]
  s_waitcnt lgkmcnt(14)
  ds_read_b128 v[116:119], v12 offset:3136
  v_mfma_f32_16x16x32_bf16 v[28:31], v[52:55], v[88:91], v[28:31]
  s_waitcnt lgkmcnt(14)
  ds_read_b64 v[148:149], v13 offset:576
  v_mfma_f32_16x16x32_bf16 v[32:35], v[56:59], v[88:91], 0
  v_mfma_f32_16x16x32_bf16 v[28:31], v[60:63], v[80:83], v[28:31]
  s_waitcnt lgkmcnt(14)
  ds_read_b64 v[150:151], v13 offset:584
  v_mfma_f32_16x16x32_bf16 v[32:35], v[60:63], v[84:87], v[32:35]
  s_waitcnt lgkmcnt(14)
  ds_read_b128 v[120:123], v12 offset:2624
  v_mfma_f32_16x16x32_bf16 v[36:39], v[60:63], v[88:91], 0
  v_mfma_f32_16x16x32_bf16 v[28:31], v[48:51], v[92:95], v[28:31]
  s_waitcnt lgkmcnt(14)
  ds_read_b64 v[152:153], v13 offset:1088
  v_mfma_f32_16x16x32_bf16 v[32:35], v[52:55], v[92:95], v[32:35]
  s_waitcnt lgkmcnt(14)
  ds_read_b64 v[154:155], v13 offset:1096
  v_mfma_f32_16x16x32_bf16 v[36:39], v[56:59], v[92:95], v[36:39]
  v_mfma_f32_16x16x32_bf16 v[40:43], v[60:63], v[92:95], 0
  s_waitcnt lgkmcnt(14)
  ds_read_b128 v[124:127], v12 offset:2112
  v_mfma_f32_16x16x32_bf16 v[32:35], v[64:67], v[80:83], v[32:35]
  s_waitcnt lgkmcnt(14)
  ds_read_b64 v[156:157], v13 offset:1600
  v_mfma_f32_16x16x32_bf16 v[36:39], v[64:67], v[84:87], v[36:39]
  v_mfma_f32_16x16x32_bf16 v[40:43], v[64:67], v[88:91], v[40:43]
  s_waitcnt lgkmcnt(14)
  ds_read_b64 v[158:159], v13 offset:1608
  v_mfma_f32_16x16x32_bf16 v[44:47], v[64:67], v[92:95], 0
  s_waitcnt lgkmcnt(14)
  ds_read_b128 v[128:131], v12 offset:1600
  v_mfma_f32_16x16x32_bf16 v[32:35], v[48:51], v[96:99], v[32:35]
  v_mfma_f32_16x16x32_bf16 v[36:39], v[52:55], v[96:99], v[36:39]
  s_waitcnt lgkmcnt(14)
  ds_read_b64 v[160:161], v13 offset:2112
  v_mfma_f32_16x16x32_bf16 v[40:43], v[56:59], v[96:99], v[40:43]
  s_waitcnt lgkmcnt(14)
  ds_read_b64 v[162:163], v13 offset:2120
  v_mfma_f32_16x16x32_bf16 v[44:47], v[60:63], v[96:99], v[44:47]
  v_mfma_f32_16x16x32_bf16 v[36:39], v[68:71], v[80:83], v[36:39]
  s_waitcnt lgkmcnt(14)
  ds_read_b128 v[132:135], v12 offset:1088
  v_mfma_f32_16x16x32_bf16 v[40:43], v[68:71], v[84:87], v[40:43]
  s_waitcnt lgkmcnt(14)
  ds_read_b64 v[164:165], v13 offset:2624
  v_mfma_f32_16x16x32_bf16 v[44:47], v[68:71], v[88:91], v[44:47]
  v_mfma_f32_16x16x32_bf16 v[36:39], v[48:51], v[100:103], v[36:39]
  s_waitcnt lgkmcnt(14)
  ds_read_b64 v[166:167], v13 offset:2632
  v_mfma_f32_16x16x32_bf16 v[40:43], v[52:55], v[100:103], v[40:43]
  s_waitcnt lgkmcnt(14)
  ds_read_b128 v[136:139], v12 offset:576
  v_mfma_f32_16x16x32_bf16 v[44:47], v[56:59], v[100:103], v[44:47]
  v_mfma_f32_16x16x32_bf16 v[40:43], v[72:75], v[80:83], v[40:43]
  s_waitcnt lgkmcnt(14)
  ds_read_b64 v[168:169], v13 offset:3136
  v_mfma_f32_16x16x32_bf16 v[44:47], v[72:75], v[84:87], v[44:47]
  s_waitcnt lgkmcnt(14)
  ds_read_b64 v[170:171], v13 offset:3144
  v_mfma_f32_16x16x32_bf16 v[40:43], v[48:51], v[104:107], v[40:43]
  v_mfma_f32_16x16x32_bf16 v[44:47], v[52:55], v[104:107], v[44:47]
  s_waitcnt lgkmcnt(14)
  ds_read_b128 v[140:143], v12 offset:64
  v_mfma_f32_16x16x32_bf16 v[44:47], v[76:79], v[80:83], v[44:47]
  s_waitcnt lgkmcnt(14)
  ds_read_b64 v[172:173], v13 offset:3648
  v_mfma_f32_16x16x32_bf16 v[44:47], v[48:51], v[108:111], v[44:47]
  s_waitcnt lgkmcnt(14)
  ds_read_b64 v[174:175], v13 offset:3656
  v_mfma_f32_16x16x32_bf16 v[16:19], v[112:115], v[144:147], v[16:19]
  v_mfma_f32_16x16x32_bf16 v[20:23], v[116:119], v[144:147], v[20:23]
  s_waitcnt lgkmcnt(14)
  ds_read_b128 v[48:51], v12 offset:3712
  v_mfma_f32_16x16x32_bf16 v[20:23], v[112:115], v[148:151], v[20:23]
  v_mfma_f32_16x16x32_bf16 v[24:27], v[116:119], v[148:151], v[24:27]
  s_waitcnt lgkmcnt(14)
  ds_read_b64 v[80:81], v13 offset:128
  v_mfma_f32_16x16x32_bf16 v[24:27], v[120:123], v[144:147], v[24:27]
  s_waitcnt lgkmcnt(14)
  ds_read_b64 v[82:83], v13 offset:136
  v_mfma_f32_16x16x32_bf16 v[28:31], v[120:123], v[148:151], v[28:31]
  v_mfma_f32_16x16x32_bf16 v[24:27], v[112:115], v[152:155], v[24:27]
  s_waitcnt lgkmcnt(14)
  ds_read_b128 v[52:55], v12 offset:3200
  v_mfma_f32_16x16x32_bf16 v[28:31], v[116:119], v[152:155], v[28:31]
  s_waitcnt lgkmcnt(14)
  ds_read_b64 v[84:85], v13 offset:640
  v_mfma_f32_16x16x32_bf16 v[32:35], v[120:123], v[152:155], v[32:35]
  v_mfma_f32_16x16x32_bf16 v[28:31], v[124:127], v[144:147], v[28:31]
  s_waitcnt lgkmcnt(14)
  ds_read_b64 v[86:87], v13 offset:648
  v_mfma_f32_16x16x32_bf16 v[32:35], v[124:127], v[148:151], v[32:35]
  s_waitcnt lgkmcnt(14)
  ds_read_b128 v[56:59], v12 offset:2688
  v_mfma_f32_16x16x32_bf16 v[36:39], v[124:127], v[152:155], v[36:39]
  v_mfma_f32_16x16x32_bf16 v[28:31], v[112:115], v[156:159], v[28:31]
  s_waitcnt lgkmcnt(14)
  ds_read_b64 v[88:89], v13 offset:1152
  v_mfma_f32_16x16x32_bf16 v[32:35], v[116:119], v[156:159], v[32:35]
  s_waitcnt lgkmcnt(14)
  ds_read_b64 v[90:91], v13 offset:1160
  v_mfma_f32_16x16x32_bf16 v[36:39], v[120:123], v[156:159], v[36:39]
  v_mfma_f32_16x16x32_bf16 v[40:43], v[124:127], v[156:159], v[40:43]
  s_waitcnt lgkmcnt(14)
  ds_read_b128 v[60:63], v12 offset:2176
  v_mfma_f32_16x16x32_bf16 v[32:35], v[128:131], v[144:147], v[32:35]
  s_waitcnt lgkmcnt(14)
  ds_read_b64 v[92:93], v13 offset:1664
  v_mfma_f32_16x16x32_bf16 v[36:39], v[128:131], v[148:151], v[36:39]
  v_mfma_f32_16x16x32_bf16 v[40:43], v[128:131], v[152:155], v[40:43]
  s_waitcnt lgkmcnt(14)
  ds_read_b64 v[94:95], v13 offset:1672
  v_mfma_f32_16x16x32_bf16 v[44:47], v[128:131], v[156:159], v[44:47]
  s_waitcnt lgkmcnt(14)
  ds_read_b128 v[64:67], v12 offset:1664
  v_mfma_f32_16x16x32_bf16 v[32:35], v[112:115], v[160:163], v[32:35]
  v_mfma_f32_16x16x32_bf16 v[36:39], v[116:119], v[160:163], v[36:39]
  s_waitcnt lgkmcnt(14)
  ds_read_b64 v[96:97], v13 offset:2176
  v_mfma_f32_16x16x32_bf16 v[40:43], v[120:123], v[160:163], v[40:43]
  s_waitcnt lgkmcnt(14)
  ds_read_b64 v[98:99], v13 offset:2184
  v_mfma_f32_16x16x32_bf16 v[44:47], v[124:127], v[160:163], v[44:47]
  v_mfma_f32_16x16x32_bf16 v[36:39], v[132:135], v[144:147], v[36:39]
  s_waitcnt lgkmcnt(14)
  ds_read_b128 v[68:71], v12 offset:1152
  v_mfma_f32_16x16x32_bf16 v[40:43], v[132:135], v[148:151], v[40:43]
  s_waitcnt lgkmcnt(14)
  ds_read_b64 v[100:101], v13 offset:2688
  v_mfma_f32_16x16x32_bf16 v[44:47], v[132:135], v[152:155], v[44:47]
  v_mfma_f32_16x16x32_bf16 v[36:39], v[112:115], v[164:167], v[36:39]
  s_waitcnt lgkmcnt(14)
  ds_read_b64 v[102:103], v13 offset:2696
  v_mfma_f32_16x16x32_bf16 v[40:43], v[116:119], v[164:167], v[40:43]
  s_waitcnt lgkmcnt(14)
  ds_read_b128 v[72:75], v12 offset:640
  v_mfma_f32_16x16x32_bf16 v[44:47], v[120:123], v[164:167], v[44:47]
  v_mfma_f32_16x16x32_bf16 v[40:43], v[136:139], v[144:147], v[40:43]
  s_waitcnt lgkmcnt(14)
  ds_read_b64 v[104:105], v13 offset:3200
  v_mfma_f32_16x16x32_bf16 v[44:47], v[136:139], v[148:151], v[44:47]
  s_waitcnt lgkmcnt(14)
  ds_read_b64 v[106:107], v13 offset:3208
  v_mfma_f32_16x16x32_bf16 v[40:43], v[112:115], v[168:171], v[40:43]
  v_mfma_f32_16x16x32_bf16 v[44:47], v[116:119], v[168:171], v[44:47]
  s_waitcnt lgkmcnt(14)
  ds_read_b128 v[76:79], v12 offset:128
  v_mfma_f32_16x16x32_bf16 v[44:47], v[140:143], v[144:147], v[44:47]
  s_waitcnt lgkmcnt(14)
  ds_read_b64 v[108:109], v13 offset:3712
  v_mfma_f32_16x16x32_bf16 v[44:47], v[112:115], v[172:175], v[44:47]
  s_waitcnt lgkmcnt(14)
  ds_read_b64 v[110:111], v13 offset:3720
  v_mfma_f32_16x16x32_bf16 v[16:19], v[48:51], v[80:83], v[16:19]
  v_mfma_f32_16x16x32_bf16 v[20:23], v[52:55], v[80:83], v[20:23]
  s_waitcnt lgkmcnt(14)
  ds_read_b128 v[112:115], v12 offset:3776
  v_mfma_f32_16x16x32_bf16 v[20:23], v[48:51], v[84:87], v[20:23]
  v_mfma_f32_16x16x32_bf16 v[24:27], v[52:55], v[84:87], v[24:27]
  s_waitcnt lgkmcnt(14)
  ds_read_b64 v[144:145], v13 offset:192
  v_mfma_f32_16x16x32_bf16 v[24:27], v[56:59], v[80:83], v[24:27]
  s_waitcnt lgkmcnt(14)
  ds_read_b64 v[146:147], v13 offset:200
  v_mfma_f32_16x16x32_bf16 v[28:31], v[56:59], v[84:87], v[28:31]
  v_mfma_f32_16x16x32_bf16 v[24:27], v[48:51], v[88:91], v[24:27]
  s_waitcnt lgkmcnt(14)
  ds_read_b128 v[116:119], v12 offset:3264
  v_mfma_f32_16x16x32_bf16 v[28:31], v[52:55], v[88:91], v[28:31]
  s_waitcnt lgkmcnt(14)
  ds_read_b64 v[148:149], v13 offset:704
  v_mfma_f32_16x16x32_bf16 v[32:35], v[56:59], v[88:91], v[32:35]
  v_mfma_f32_16x16x32_bf16 v[28:31], v[60:63], v[80:83], v[28:31]
  s_waitcnt lgkmcnt(14)
  ds_read_b64 v[150:151], v13 offset:712
  v_mfma_f32_16x16x32_bf16 v[32:35], v[60:63], v[84:87], v[32:35]
  s_waitcnt lgkmcnt(14)
  ds_read_b128 v[120:123], v12 offset:2752
  v_mfma_f32_16x16x32_bf16 v[36:39], v[60:63], v[88:91], v[36:39]
  v_mfma_f32_16x16x32_bf16 v[28:31], v[48:51], v[92:95], v[28:31]
  s_waitcnt lgkmcnt(14)
  ds_read_b64 v[152:153], v13 offset:1216
  v_mfma_f32_16x16x32_bf16 v[32:35], v[52:55], v[92:95], v[32:35]
  s_waitcnt lgkmcnt(14)
  ds_read_b64 v[154:155], v13 offset:1224
  v_mfma_f32_16x16x32_bf16 v[36:39], v[56:59], v[92:95], v[36:39]
  v_mfma_f32_16x16x32_bf16 v[40:43], v[60:63], v[92:95], v[40:43]
  s_waitcnt lgkmcnt(14)
  ds_read_b128 v[124:127], v12 offset:2240
  v_mfma_f32_16x16x32_bf16 v[32:35], v[64:67], v[80:83], v[32:35]
  s_waitcnt lgkmcnt(14)
  ds_read_b64 v[156:157], v13 offset:1728
  v_mfma_f32_16x16x32_bf16 v[36:39], v[64:67], v[84:87], v[36:39]
  v_mfma_f32_16x16x32_bf16 v[40:43], v[64:67], v[88:91], v[40:43]
  s_waitcnt lgkmcnt(14)
  ds_read_b64 v[158:159], v13 offset:1736
  v_mfma_f32_16x16x32_bf16 v[44:47], v[64:67], v[92:95], v[44:47]
  s_waitcnt lgkmcnt(14)
  ds_read_b128 v[128:131], v12 offset:1728
  v_mfma_f32_16x16x32_bf16 v[32:35], v[48:51], v[96:99], v[32:35]
  v_mfma_f32_16x16x32_bf16 v[36:39], v[52:55], v[96:99], v[36:39]
  s_waitcnt lgkmcnt(14)
  ds_read_b64 v[160:161], v13 offset:2240
  v_mfma_f32_16x16x32_bf16 v[40:43], v[56:59], v[96:99], v[40:43]
  s_waitcnt lgkmcnt(14)
  ds_read_b64 v[162:163], v13 offset:2248
  v_mfma_f32_16x16x32_bf16 v[44:47], v[60:63], v[96:99], v[44:47]
  v_mfma_f32_16x16x32_bf16 v[36:39], v[68:71], v[80:83], v[36:39]
  s_waitcnt lgkmcnt(14)
  ds_read_b128 v[132:135], v12 offset:1216
  v_mfma_f32_16x16x32_bf16 v[40:43], v[68:71], v[84:87], v[40:43]
  s_waitcnt lgkmcnt(14)
  ds_read_b64 v[164:165], v13 offset:2752
  v_mfma_f32_16x16x32_bf16 v[44:47], v[68:71], v[88:91], v[44:47]
  v_mfma_f32_16x16x32_bf16 v[36:39], v[48:51], v[100:103], v[36:39]
  s_waitcnt lgkmcnt(14)
  ds_read_b64 v[166:167], v13 offset:2760
  v_mfma_f32_16x16x32_bf16 v[40:43], v[52:55], v[100:103], v[40:43]
  s_waitcnt lgkmcnt(14)
  ds_read_b128 v[136:139], v12 offset:704
  v_mfma_f32_16x16x32_bf16 v[44:47], v[56:59], v[100:103], v[44:47]
  v_mfma_f32_16x16x32_bf16 v[40:43], v[72:75], v[80:83], v[40:43]
  s_waitcnt lgkmcnt(14)
  ds_read_b64 v[168:169], v13 offset:3264
  v_mfma_f32_16x16x32_bf16 v[44:47], v[72:75], v[84:87], v[44:47]
  s_waitcnt lgkmcnt(14)
  ds_read_b64 v[170:171], v13 offset:3272
  v_mfma_f32_16x16x32_bf16 v[40:43], v[48:51], v[104:107], v[40:43]
  v_mfma_f32_16x16x32_bf16 v[44:47], v[52:55], v[104:107], v[44:47]
  s_waitcnt lgkmcnt(14)
  ds_read_b128 v[140:143], v12 offset:192
  v_mfma_f32_16x16x32_bf16 v[44:47], v[76:79], v[80:83], v[44:47]
  s_waitcnt lgkmcnt(14)
  ds_read_b64 v[172:173], v13 offset:3776
  v_mfma_f32_16x16x32_bf16 v[44:47], v[48:51], v[108:111], v[44:47]
  s_waitcnt lgkmcnt(14)
  ds_read_b64 v[174:175], v13 offset:3784
  v_bfe_u32 v2, v1, 2, 2
  v_lshrrev_b32 v3, 5, v1
  v_lshl_add_u32 v2, v3, 2, v2
  v_lshlrev_b32 v180, 6, v2
  v_bfe_u32 v3, v1, 4, 1
  v_lshl_add_u32 v180, v3, 5, v180
  v_and_b32 v3, 3, v1
  v_lshl_add_u32 v180, v3, 3, v180
  s_lshl_b32 s64, s82, 10
  s_add_u32 s64, s64, 159744
  v_add_u32 v180, s64, v180
  s_waitcnt vmcnt(0)
  s_waitcnt lgkmcnt(14)
  ds_read_b64_tr_b16 v[176:177], v180
  s_waitcnt lgkmcnt(14)
  ds_read_b64_tr_b16 v[178:179], v180 offset:512
  v_lshlrev_b32 v2, 4, v1
  s_lshl_b32 s64, s78, 10
  s_add_u32 s64, s64, 6291456
  s_waitcnt lgkmcnt(0)
  buffer_store_dwordx4 v[176:179], v2, s[48:51], s64 offen sc1
  v_mfma_f32_16x16x32_bf16 v[16:19], v[112:115], v[144:147], v[16:19]
  v_mfma_f32_16x16x32_bf16 v[20:23], v[116:119], v[144:147], v[20:23]
  v_mfma_f32_16x16x32_bf16 v[20:23], v[112:115], v[148:151], v[20:23]
  v_mfma_f32_16x16x32_bf16 v[24:27], v[116:119], v[148:151], v[24:27]
  v_mfma_f32_16x16x32_bf16 v[24:27], v[120:123], v[144:147], v[24:27]
  v_mfma_f32_16x16x32_bf16 v[28:31], v[120:123], v[148:151], v[28:31]
  v_mfma_f32_16x16x32_bf16 v[24:27], v[112:115], v[152:155], v[24:27]
  v_mfma_f32_16x16x32_bf16 v[28:31], v[116:119], v[152:155], v[28:31]
  v_mfma_f32_16x16x32_bf16 v[32:35], v[120:123], v[152:155], v[32:35]
  v_mfma_f32_16x16x32_bf16 v[28:31], v[124:127], v[144:147], v[28:31]
  v_mfma_f32_16x16x32_bf16 v[32:35], v[124:127], v[148:151], v[32:35]
  v_mfma_f32_16x16x32_bf16 v[36:39], v[124:127], v[152:155], v[36:39]
  v_mfma_f32_16x16x32_bf16 v[28:31], v[112:115], v[156:159], v[28:31]
  v_mfma_f32_16x16x32_bf16 v[32:35], v[116:119], v[156:159], v[32:35]
  v_mfma_f32_16x16x32_bf16 v[36:39], v[120:123], v[156:159], v[36:39]
  v_mfma_f32_16x16x32_bf16 v[40:43], v[124:127], v[156:159], v[40:43]
  v_mfma_f32_16x16x32_bf16 v[32:35], v[128:131], v[144:147], v[32:35]
  v_mfma_f32_16x16x32_bf16 v[36:39], v[128:131], v[148:151], v[36:39]
  v_mfma_f32_16x16x32_bf16 v[40:43], v[128:131], v[152:155], v[40:43]
  v_mfma_f32_16x16x32_bf16 v[44:47], v[128:131], v[156:159], v[44:47]
  v_mfma_f32_16x16x32_bf16 v[32:35], v[112:115], v[160:163], v[32:35]
  v_mfma_f32_16x16x32_bf16 v[36:39], v[116:119], v[160:163], v[36:39]
  v_mfma_f32_16x16x32_bf16 v[40:43], v[120:123], v[160:163], v[40:43]
  v_mfma_f32_16x16x32_bf16 v[44:47], v[124:127], v[160:163], v[44:47]
  v_mfma_f32_16x16x32_bf16 v[36:39], v[132:135], v[144:147], v[36:39]
  v_mfma_f32_16x16x32_bf16 v[40:43], v[132:135], v[148:151], v[40:43]
  v_mfma_f32_16x16x32_bf16 v[44:47], v[132:135], v[152:155], v[44:47]
  v_mfma_f32_16x16x32_bf16 v[36:39], v[112:115], v[164:167], v[36:39]
  v_mfma_f32_16x16x32_bf16 v[40:43], v[116:119], v[164:167], v[40:43]
  v_mfma_f32_16x16x32_bf16 v[44:47], v[120:123], v[164:167], v[44:47]
  v_mfma_f32_16x16x32_bf16 v[40:43], v[136:139], v[144:147], v[40:43]
  v_mfma_f32_16x16x32_bf16 v[44:47], v[136:139], v[148:151], v[44:47]
  v_mfma_f32_16x16x32_bf16 v[40:43], v[112:115], v[168:171], v[40:43]
  v_mfma_f32_16x16x32_bf16 v[44:47], v[116:119], v[168:171], v[44:47]
  v_mfma_f32_16x16x32_bf16 v[44:47], v[140:143], v[144:147], v[44:47]
  v_mfma_f32_16x16x32_bf16 v[44:47], v[112:115], v[172:175], v[44:47]
  v_lshlrev_b32 v2, 4, v1
  s_lshl_b32 s64, s34, 12
  s_add_u32 s64, s64, 126976
  v_add_u32 v4, s64, v2
  s_xor_b32 s65, s34, 1
  s_lshl_b32 s65, s65, 12
  s_add_u32 s65, s65, 126976
  v_add_u32 v12, s65, v2
  ds_write_b128 v4, v[32:35] offset:0
  ds_write_b128 v4, v[36:39] offset:1024
  ds_write_b128 v4, v[40:43] offset:2048
  ds_write_b128 v4, v[44:47] offset:3072
  v_lshrrev_b32 v2, 1, v10
  v_lshlrev_b32 v13, 6, v2
  v_lshl_add_u32 v13, v11, 4, v13
  v_and_b32 v2, 1, v10
  v_lshl_add_u32 v13, v2, 3, v13
  s_add_u32 s64, s66, s67
  s_lshl_b32 s64, s64, 12
  s_add_u32 s64, s64, 4194304
  s_waitcnt lgkmcnt(0)
  s_barrier
  ds_read_b128 v[48:51], v12 offset:0
  ds_read_b128 v[52:55], v12 offset:1024
  ds_read_b128 v[56:59], v12 offset:2048
  ds_read_b128 v[60:63], v12 offset:3072
  s_waitcnt lgkmcnt(3)
  v_pk_add_f32 v[48:49], v[48:49], v[16:17]
  v_pk_add_f32 v[50:51], v[50:51], v[18:19]
  v_cvt_pk_bf16_f32 v48, v48, v49
  v_cvt_pk_bf16_f32 v49, v50, v51
  buffer_store_dwordx2 v[48:49], v13, s[48:51], s64 offen offset:0 sc1
  s_waitcnt lgkmcnt(2)
  v_pk_add_f32 v[52:53], v[52:53], v[20:21]
  v_pk_add_f32 v[54:55], v[54:55], v[22:23]
  v_cvt_pk_bf16_f32 v52, v52, v53
  v_cvt_pk_bf16_f32 v53, v54, v55
  buffer_store_dwordx2 v[52:53], v13, s[48:51], s64 offen offset:512 sc1
  s_waitcnt lgkmcnt(1)
  v_pk_add_f32 v[56:57], v[56:57], v[24:25]
  v_pk_add_f32 v[58:59], v[58:59], v[26:27]
  v_cvt_pk_bf16_f32 v56, v56, v57
  v_cvt_pk_bf16_f32 v57, v58, v59
  buffer_store_dwordx2 v[56:57], v13, s[48:51], s64 offen offset:1024 sc1
  s_waitcnt lgkmcnt(0)
  v_pk_add_f32 v[60:61], v[60:61], v[28:29]
  v_pk_add_f32 v[62:63], v[62:63], v[30:31]
  v_cvt_pk_bf16_f32 v60, v60, v61
  v_cvt_pk_bf16_f32 v61, v62, v63
  buffer_store_dwordx2 v[60:61], v13, s[48:51], s64 offen offset:1536 sc1
  s_endpgm
L_mix_kernel_B1:
  v_bfe_u32 v200, v10, 3, 1
  v_add3_u32 v200, v200, v10, 3
  v_lshrrev_b32 v200, 3, v200
  v_lshlrev_b32 v200, 1, v200
  v_add_u32 v200, 51, v200
  v_and_b32 v2, 15, v200
  v_xor_b32 v2, v2, v11
  v_lshlrev_b32 v2, 4, v2
  v_lshl_add_u32 v2, v200, 9, v2
  v_add_u32 v56, s76, v2
  v_xor_b32 v57, 64, v56
  v_xor_b32 v58, 128, v56
  v_xor_b32 v59, 192, v56
  v_add_u32 v200, 6, v200
  v_and_b32 v2, 15, v200
  v_xor_b32 v2, v2, v11
  v_lshlrev_b32 v2, 4, v2
  v_lshl_add_u32 v2, v200, 9, v2
  v_add_u32 v60, s76, v2
  v_xor_b32 v61, 64, v60
  v_xor_b32 v62, 128, v60
  v_xor_b32 v63, 192, v60
  s_waitcnt vmcnt(4)
  v_lshlrev_b32 v70, 16, v15
  v_and_b32 v71, 0xffff0000, v15
  v_mul_f32 v70, 0x3fb8aa3b, v70
  v_mul_f32 v71, 0x3fb8aa3b, v71
  v_exp_f32 v70, v70
  v_exp_f32 v71, v71
  s_waitcnt vmcnt(3)
  v_lshlrev_b32 v72, 16, v16
  v_and_b32 v73, 0xffff0000, v16
  v_cvt_pk_bf16_f32 v2, v70, v71
  v_mul_f32 v72, v72, v68
  v_mul_f32 v73, v73, v68
  v_lshlrev_b32 v70, 16, v2
  v_and_b32 v71, 0xffff0000, v2
  v_mul_f32 v72, 0x3e22f983, v72
  v_mul_f32 v73, 0x3e22f983, v73
  v_mul_f32 v70, v70, v68
  v_mul_f32 v71, v71, v68
  v_mul_f32 v70, 0xbfb8aa3b, v70
  v_mul_f32 v71, 0xbfb8aa3b, v71
  v_exp_f32 v82, v70
  v_exp_f32 v84, v71
  v_fract_f32 v83, v72
  v_fract_f32 v85, v73
  v_cos_f32 v98, v83
  v_cos_f32 v100, v85
  v_sin_f32 v99, v83
  v_sin_f32 v101, v85
  v_pk_mul_f32 v[98:99], v[98:99], v[82:83] op_sel_hi:[1,0]
  v_pk_mul_f32 v[100:101], v[100:101], v[84:85] op_sel_hi:[1,0]
  v_mov_b32 v86, 0x3f80
  v_mov_b32 v87, 0x3f80
  ds_write_b64 v36, v[86:87] offset:16384
  v_mul_f32 v82, 0x44000000, v70
  v_mul_f32 v84, 0x44000000, v71
  v_mul_f32 v83, 0x44000000, v72
  v_mul_f32 v85, 0x44000000, v73
  v_exp_f32 v82, v82
  v_exp_f32 v84, v84
  v_fract_f32 v83, v83
  v_fract_f32 v85, v85
  v_cos_f32 v118, v83
  v_cos_f32 v120, v85
  v_sin_f32 v119, v83
  v_sin_f32 v121, v85
  v_pk_mul_f32 v[118:119], v[118:119], v[82:83] op_sel_hi:[1,0]
  v_pk_mul_f32 v[120:121], v[120:121], v[84:85] op_sel_hi:[1,0]
  v_cvt_pk_bf16_f32 v88, v98, v99
  v_cvt_pk_bf16_f32 v89, v100, v101
  ds_write_b64 v37, v[88:89] offset:16896
  buffer_load_dwordx2 v[26:27], v34, s[40:43], 0 offen offset:0
  v_cvt_pk_bf16_f32 v86, v118, v119
  v_cvt_pk_bf16_f32 v87, v120, v121
  ds_write_b64 v38, v[86:87] offset:25600
  v_pk_mul_f32 v[78:79], v[98:99], v[98:99] op_sel:[0,0] op_sel_hi:[0,1]
  v_pk_mul_f32 v[80:81], v[100:101], v[100:101] op_sel:[0,0] op_sel_hi:[0,1]
  v_pk_fma_f32 v[90:91], v[98:99], v[98:99], v[78:79] op_sel:[1,1,0] op_sel_hi:[1,0,1] neg_lo:[0,1,0]
  v_pk_fma_f32 v[92:93], v[100:101], v[100:101], v[80:81] op_sel:[1,1,0] op_sel_hi:[1,0,1] neg_lo:[0,1,0]
  v_cvt_pk_bf16_f32 v88, v90, v91
  v_cvt_pk_bf16_f32 v89, v92, v93
  ds_write_b64 v38, v[88:89] offset:17408
  v_pk_mul_f32 v[78:79], v[90:91], v[98:99] op_sel:[0,0] op_sel_hi:[0,1]
  v_pk_mul_f32 v[80:81], v[92:93], v[100:101] op_sel:[0,0] op_sel_hi:[0,1]
  v_pk_fma_f32 v[90:91], v[90:91], v[98:99], v[78:79] op_sel:[1,1,0] op_sel_hi:[1,0,1] neg_lo:[0,1,0]
  v_pk_fma_f32 v[92:93], v[92:93], v[100:101], v[80:81] op_sel:[1,1,0] op_sel_hi:[1,0,1] neg_lo:[0,1,0]
  v_cvt_pk_bf16_f32 v86, v90, v91
  v_cvt_pk_bf16_f32 v87, v92, v93
  ds_write_b64 v39, v[86:87] offset:17920
  v_pk_mul_f32 v[78:79], v[90:91], v[98:99] op_sel:[0,0] op_sel_hi:[0,1]
  v_pk_mul_f32 v[80:81], v[92:93], v[100:101] op_sel:[0,0] op_sel_hi:[0,1]
  v_pk_fma_f32 v[102:103], v[90:91], v[98:99], v[78:79] op_sel:[1,1,0] op_sel_hi:[1,0,1] neg_lo:[0,1,0]
  v_pk_fma_f32 v[104:105], v[92:93], v[100:101], v[80:81] op_sel:[1,1,0] op_sel_hi:[1,0,1] neg_lo:[0,1,0]
  v_cvt_pk_bf16_f32 v88, v102, v103
  v_cvt_pk_bf16_f32 v89, v104, v105
  ds_write_b64 v40, v[88:89] offset:18432
  v_pk_mul_f32 v[82:83], v[118:119], v[102:103] op_sel:[0,0] op_sel_hi:[0,1]
  v_pk_mul_f32 v[84:85], v[120:121], v[104:105] op_sel:[0,0] op_sel_hi:[0,1]
  v_pk_fma_f32 v[94:95], v[118:119], v[102:103], v[82:83] op_sel:[1,1,0] op_sel_hi:[1,0,1] neg_lo:[0,1,0]
  v_pk_fma_f32 v[96:97], v[120:121], v[104:105], v[84:85] op_sel:[1,1,0] op_sel_hi:[1,0,1] neg_lo:[0,1,0]
  v_cvt_pk_bf16_f32 v86, v94, v95
  v_cvt_pk_bf16_f32 v87, v96, v97
  ds_write_b64 v40, v[86:87] offset:26624
  v_pk_mul_f32 v[78:79], v[102:103], v[98:99] op_sel:[0,0] op_sel_hi:[0,1]
  v_pk_mul_f32 v[80:81], v[104:105], v[100:101] op_sel:[0,0] op_sel_hi:[0,1]
  v_pk_fma_f32 v[90:91], v[102:103], v[98:99], v[78:79] op_sel:[1,1,0] op_sel_hi:[1,0,1] neg_lo:[0,1,0]
  v_pk_fma_f32 v[92:93], v[104:105], v[100:101], v[80:81] op_sel:[1,1,0] op_sel_hi:[1,0,1] neg_lo:[0,1,0]
  v_cvt_pk_bf16_f32 v88, v90, v91
  v_cvt_pk_bf16_f32 v89, v92, v93
  ds_write_b64 v41, v[88:89] offset:18944
  v_pk_mul_f32 v[78:79], v[90:91], v[98:99] op_sel:[0,0] op_sel_hi:[0,1]
  v_pk_mul_f32 v[80:81], v[92:93], v[100:101] op_sel:[0,0] op_sel_hi:[0,1]
  v_pk_fma_f32 v[90:91], v[90:91], v[98:99], v[78:79] op_sel:[1,1,0] op_sel_hi:[1,0,1] neg_lo:[0,1,0]
  v_pk_fma_f32 v[92:93], v[92:93], v[100:101], v[80:81] op_sel:[1,1,0] op_sel_hi:[1,0,1] neg_lo:[0,1,0]
  v_cvt_pk_bf16_f32 v86, v90, v91
  v_cvt_pk_bf16_f32 v87, v92, v93
  ds_write_b64 v42, v[86:87] offset:19456
  v_pk_mul_f32 v[78:79], v[90:91], v[98:99] op_sel:[0,0] op_sel_hi:[0,1]
  v_pk_mul_f32 v[80:81], v[92:93], v[100:101] op_sel:[0,0] op_sel_hi:[0,1]
  v_pk_fma_f32 v[90:91], v[90:91], v[98:99], v[78:79] op_sel:[1,1,0] op_sel_hi:[1,0,1] neg_lo:[0,1,0]
  v_pk_fma_f32 v[92:93], v[92:93], v[100:101], v[80:81] op_sel:[1,1,0] op_sel_hi:[1,0,1] neg_lo:[0,1,0]
  v_cvt_pk_bf16_f32 v88, v90, v91
  v_cvt_pk_bf16_f32 v89, v92, v93
  ds_write_b64 v43, v[88:89] offset:19968
  v_pk_mul_f32 v[78:79], v[90:91], v[98:99] op_sel:[0,0] op_sel_hi:[0,1]
  v_pk_mul_f32 v[80:81], v[92:93], v[100:101] op_sel:[0,0] op_sel_hi:[0,1]
  v_pk_fma_f32 v[106:107], v[90:91], v[98:99], v[78:79] op_sel:[1,1,0] op_sel_hi:[1,0,1] neg_lo:[0,1,0]
  v_pk_fma_f32 v[108:109], v[92:93], v[100:101], v[80:81] op_sel:[1,1,0] op_sel_hi:[1,0,1] neg_lo:[0,1,0]
  v_cvt_pk_bf16_f32 v86, v106, v107
  v_cvt_pk_bf16_f32 v87, v108, v109
  ds_write_b64 v44, v[86:87] offset:20480
  v_pk_mul_f32 v[82:83], v[118:119], v[106:107] op_sel:[0,0] op_sel_hi:[0,1]
  v_pk_mul_f32 v[84:85], v[120:121], v[108:109] op_sel:[0,0] op_sel_hi:[0,1]
  v_pk_fma_f32 v[94:95], v[118:119], v[106:107], v[82:83] op_sel:[1,1,0] op_sel_hi:[1,0,1] neg_lo:[0,1,0]
  v_pk_fma_f32 v[96:97], v[120:121], v[108:109], v[84:85] op_sel:[1,1,0] op_sel_hi:[1,0,1] neg_lo:[0,1,0]
  v_cvt_pk_bf16_f32 v88, v94, v95
  v_cvt_pk_bf16_f32 v89, v96, v97
  ds_write_b64 v42, v[88:89] offset:27648
  buffer_load_dwordx2 v[28:29], v34, s[40:43], 0 offen offset:1024
  v_pk_mul_f32 v[78:79], v[106:107], v[98:99] op_sel:[0,0] op_sel_hi:[0,1]
  v_pk_mul_f32 v[80:81], v[108:109], v[100:101] op_sel:[0,0] op_sel_hi:[0,1]
  v_pk_fma_f32 v[90:91], v[106:107], v[98:99], v[78:79] op_sel:[1,1,0] op_sel_hi:[1,0,1] neg_lo:[0,1,0]
  v_pk_fma_f32 v[92:93], v[108:109], v[100:101], v[80:81] op_sel:[1,1,0] op_sel_hi:[1,0,1] neg_lo:[0,1,0]
  v_cvt_pk_bf16_f32 v86, v90, v91
  v_cvt_pk_bf16_f32 v87, v92, v93
  ds_write_b64 v45, v[86:87] offset:20992
  v_pk_mul_f32 v[78:79], v[90:91], v[98:99] op_sel:[0,0] op_sel_hi:[0,1]
  v_pk_mul_f32 v[80:81], v[92:93], v[100:101] op_sel:[0,0] op_sel_hi:[0,1]
  v_pk_fma_f32 v[90:91], v[90:91], v[98:99], v[78:79] op_sel:[1,1,0] op_sel_hi:[1,0,1] neg_lo:[0,1,0]
  v_pk_fma_f32 v[92:93], v[92:93], v[100:101], v[80:81] op_sel:[1,1,0] op_sel_hi:[1,0,1] neg_lo:[0,1,0]
  v_cvt_pk_bf16_f32 v88, v90, v91
  v_cvt_pk_bf16_f32 v89, v92, v93
  ds_write_b64 v46, v[88:89] offset:21504
  v_pk_mul_f32 v[78:79], v[90:91], v[98:99] op_sel:[0,0] op_sel_hi:[0,1]
  v_pk_mul_f32 v[80:81], v[92:93], v[100:101] op_sel:[0,0] op_sel_hi:[0,1]
  v_pk_fma_f32 v[90:91], v[90:91], v[98:99], v[78:79] op_sel:[1,1,0] op_sel_hi:[1,0,1] neg_lo:[0,1,0]
  v_pk_fma_f32 v[92:93], v[92:93], v[100:101], v[80:81] op_sel:[1,1,0] op_sel_hi:[1,0,1] neg_lo:[0,1,0]
  v_cvt_pk_bf16_f32 v86, v90, v91
  v_cvt_pk_bf16_f32 v87, v92, v93
  ds_write_b64 v47, v[86:87] offset:22016
  v_pk_mul_f32 v[78:79], v[90:91], v[98:99] op_sel:[0,0] op_sel_hi:[0,1]
  v_pk_mul_f32 v[80:81], v[92:93], v[100:101] op_sel:[0,0] op_sel_hi:[0,1]
  v_pk_fma_f32 v[110:111], v[90:91], v[98:99], v[78:79] op_sel:[1,1,0] op_sel_hi:[1,0,1] neg_lo:[0,1,0]
  v_pk_fma_f32 v[112:113], v[92:93], v[100:101], v[80:81] op_sel:[1,1,0] op_sel_hi:[1,0,1] neg_lo:[0,1,0]
  v_cvt_pk_bf16_f32 v88, v110, v111
  v_cvt_pk_bf16_f32 v89, v112, v113
  s_waitcnt lgkmcnt(14)
  ds_write_b64 v48, v[88:89] offset:22528
  v_pk_mul_f32 v[82:83], v[118:119], v[110:111] op_sel:[0,0] op_sel_hi:[0,1]
  v_pk_mul_f32 v[84:85], v[120:121], v[112:113] op_sel:[0,0] op_sel_hi:[0,1]
  v_pk_fma_f32 v[94:95], v[118:119], v[110:111], v[82:83] op_sel:[1,1,0] op_sel_hi:[1,0,1] neg_lo:[0,1,0]
  v_pk_fma_f32 v[96:97], v[120:121], v[112:113], v[84:85] op_sel:[1,1,0] op_sel_hi:[1,0,1] neg_lo:[0,1,0]
  v_cvt_pk_bf16_f32 v86, v94, v95
  v_cvt_pk_bf16_f32 v87, v96, v97
  s_waitcnt lgkmcnt(14)
  ds_write_b64 v44, v[86:87] offset:28672
  v_pk_mul_f32 v[78:79], v[110:111], v[98:99] op_sel:[0,0] op_sel_hi:[0,1]
  v_pk_mul_f32 v[80:81], v[112:113], v[100:101] op_sel:[0,0] op_sel_hi:[0,1]
  v_pk_fma_f32 v[90:91], v[110:111], v[98:99], v[78:79] op_sel:[1,1,0] op_sel_hi:[1,0,1] neg_lo:[0,1,0]
  v_pk_fma_f32 v[92:93], v[112:113], v[100:101], v[80:81] op_sel:[1,1,0] op_sel_hi:[1,0,1] neg_lo:[0,1,0]
  v_cvt_pk_bf16_f32 v88, v90, v91
  v_cvt_pk_bf16_f32 v89, v92, v93
  s_waitcnt lgkmcnt(14)
  ds_write_b64 v49, v[88:89] offset:23040
  v_pk_mul_f32 v[78:79], v[90:91], v[98:99] op_sel:[0,0] op_sel_hi:[0,1]
  v_pk_mul_f32 v[80:81], v[92:93], v[100:101] op_sel:[0,0] op_sel_hi:[0,1]
  v_pk_fma_f32 v[90:91], v[90:91], v[98:99], v[78:79] op_sel:[1,1,0] op_sel_hi:[1,0,1] neg_lo:[0,1,0]
  v_pk_fma_f32 v[92:93], v[92:93], v[100:101], v[80:81] op_sel:[1,1,0] op_sel_hi:[1,0,1] neg_lo:[0,1,0]
  v_cvt_pk_bf16_f32 v86, v90, v91
  v_cvt_pk_bf16_f32 v87, v92, v93
  s_waitcnt lgkmcnt(14)
  ds_write_b64 v50, v[86:87] offset:23552
  v_pk_mul_f32 v[78:79], v[90:91], v[98:99] op_sel:[0,0] op_sel_hi:[0,1]
  v_pk_mul_f32 v[80:81], v[92:93], v[100:101] op_sel:[0,0] op_sel_hi:[0,1]
  v_pk_fma_f32 v[90:91], v[90:91], v[98:99], v[78:79] op_sel:[1,1,0] op_sel_hi:[1,0,1] neg_lo:[0,1,0]
  v_pk_fma_f32 v[92:93], v[92:93], v[100:101], v[80:81] op_sel:[1,1,0] op_sel_hi:[1,0,1] neg_lo:[0,1,0]
  v_cvt_pk_bf16_f32 v88, v90, v91
  v_cvt_pk_bf16_f32 v89, v92, v93
  s_waitcnt lgkmcnt(14)
  ds_write_b64 v51, v[88:89] offset:24064
  v_pk_mul_f32 v[78:79], v[90:91], v[98:99] op_sel:[0,0] op_sel_hi:[0,1]
  v_pk_mul_f32 v[80:81], v[92:93], v[100:101] op_sel:[0,0] op_sel_hi:[0,1]
  v_pk_fma_f32 v[114:115], v[90:91], v[98:99], v[78:79] op_sel:[1,1,0] op_sel_hi:[1,0,1] neg_lo:[0,1,0]
  v_pk_fma_f32 v[116:117], v[92:93], v[100:101], v[80:81] op_sel:[1,1,0] op_sel_hi:[1,0,1] neg_lo:[0,1,0]
  v_cvt_pk_bf16_f32 v86, v114, v115
  v_cvt_pk_bf16_f32 v87, v116, v117
  s_waitcnt lgkmcnt(14)
  ds_write_b64 v37, v[86:87] offset:25088
  v_pk_mul_f32 v[82:83], v[118:119], v[114:115] op_sel:[0,0] op_sel_hi:[0,1]
  v_pk_mul_f32 v[84:85], v[120:121], v[116:117] op_sel:[0,0] op_sel_hi:[0,1]
  v_pk_fma_f32 v[94:95], v[118:119], v[114:115], v[82:83] op_sel:[1,1,0] op_sel_hi:[1,0,1] neg_lo:[0,1,0]
  v_pk_fma_f32 v[96:97], v[120:121], v[116:117], v[84:85] op_sel:[1,1,0] op_sel_hi:[1,0,1] neg_lo:[0,1,0]
  v_cvt_pk_bf16_f32 v88, v94, v95
  v_cvt_pk_bf16_f32 v89, v96, v97
  s_waitcnt lgkmcnt(14)
  ds_write_b64 v46, v[88:89] offset:29696
  buffer_load_dwordx2 v[30:31], v34, s[40:43], 0 offen offset:2048
  v_mul_f32 v82, 0x44800000, v70
  v_mul_f32 v84, 0x44800000, v71
  v_mul_f32 v83, 0x44800000, v72
  v_mul_f32 v85, 0x44800000, v73
  v_exp_f32 v82, v82
  v_exp_f32 v84, v84
  v_fract_f32 v83, v83
  v_fract_f32 v85, v85
  v_cos_f32 v118, v83
  v_cos_f32 v120, v85
  v_sin_f32 v119, v83
  v_sin_f32 v121, v85
  v_pk_mul_f32 v[118:119], v[118:119], v[82:83] op_sel_hi:[1,0]
  v_pk_mul_f32 v[120:121], v[120:121], v[84:85] op_sel_hi:[1,0]
  v_cvt_pk_bf16_f32 v86, v118, v119
  v_cvt_pk_bf16_f32 v87, v120, v121
  s_waitcnt lgkmcnt(14)
  ds_write_b64 v39, v[86:87] offset:26112
  v_pk_mul_f32 v[78:79], v[118:119], v[106:107] op_sel:[0,0] op_sel_hi:[0,1]
  v_pk_mul_f32 v[80:81], v[120:121], v[108:109] op_sel:[0,0] op_sel_hi:[0,1]
  v_pk_fma_f32 v[94:95], v[118:119], v[106:107], v[78:79] op_sel:[1,1,0] op_sel_hi:[1,0,1] neg_lo:[0,1,0]
  v_pk_fma_f32 v[96:97], v[120:121], v[108:109], v[80:81] op_sel:[1,1,0] op_sel_hi:[1,0,1] neg_lo:[0,1,0]
  v_cvt_pk_bf16_f32 v88, v94, v95
  v_cvt_pk_bf16_f32 v89, v96, v97
  s_waitcnt lgkmcnt(14)
  ds_write_b64 v41, v[88:89] offset:27136
  v_pk_mul_f32 v[82:83], v[118:119], v[114:115] op_sel:[0,0] op_sel_hi:[0,1]
  v_pk_mul_f32 v[84:85], v[120:121], v[116:117] op_sel:[0,0] op_sel_hi:[0,1]
  v_pk_fma_f32 v[94:95], v[118:119], v[114:115], v[82:83] op_sel:[1,1,0] op_sel_hi:[1,0,1] neg_lo:[0,1,0]
  v_pk_fma_f32 v[96:97], v[120:121], v[116:117], v[84:85] op_sel:[1,1,0] op_sel_hi:[1,0,1] neg_lo:[0,1,0]
  v_cvt_pk_bf16_f32 v86, v94, v95
  v_cvt_pk_bf16_f32 v87, v96, v97
  s_waitcnt lgkmcnt(14)
  ds_write_b64 v43, v[86:87] offset:28160
  v_mul_f32 v82, 0x44c00000, v70
  v_mul_f32 v84, 0x44c00000, v71
  v_mul_f32 v83, 0x44c00000, v72
  v_mul_f32 v85, 0x44c00000, v73
  v_exp_f32 v82, v82
  v_exp_f32 v84, v84
  v_fract_f32 v83, v83
  v_fract_f32 v85, v85
  v_cos_f32 v118, v83
  v_cos_f32 v120, v85
  v_sin_f32 v119, v83
  v_sin_f32 v121, v85
  v_pk_mul_f32 v[118:119], v[118:119], v[82:83] op_sel_hi:[1,0]
  v_pk_mul_f32 v[120:121], v[120:121], v[84:85] op_sel_hi:[1,0]
  v_cvt_pk_bf16_f32 v88, v118, v119
  v_cvt_pk_bf16_f32 v89, v120, v121
  s_waitcnt lgkmcnt(14)
  ds_write_b64 v45, v[88:89] offset:29184
  v_pk_mul_f32 v[78:79], v[118:119], v[106:107] op_sel:[0,0] op_sel_hi:[0,1]
  v_pk_mul_f32 v[80:81], v[120:121], v[108:109] op_sel:[0,0] op_sel_hi:[0,1]
  v_pk_fma_f32 v[94:95], v[118:119], v[106:107], v[78:79] op_sel:[1,1,0] op_sel_hi:[1,0,1] neg_lo:[0,1,0]
  v_pk_fma_f32 v[96:97], v[120:121], v[108:109], v[80:81] op_sel:[1,1,0] op_sel_hi:[1,0,1] neg_lo:[0,1,0]
  v_cvt_pk_bf16_f32 v86, v94, v95
  v_cvt_pk_bf16_f32 v87, v96, v97
  s_waitcnt lgkmcnt(14)
  ds_write_b64 v47, v[86:87] offset:30208
  v_pk_mul_f32 v[82:83], v[118:119], v[114:115] op_sel:[0,0] op_sel_hi:[0,1]
  v_pk_mul_f32 v[84:85], v[120:121], v[116:117] op_sel:[0,0] op_sel_hi:[0,1]
  v_pk_fma_f32 v[94:95], v[118:119], v[114:115], v[82:83] op_sel:[1,1,0] op_sel_hi:[1,0,1] neg_lo:[0,1,0]
  v_pk_fma_f32 v[96:97], v[120:121], v[116:117], v[84:85] op_sel:[1,1,0] op_sel_hi:[1,0,1] neg_lo:[0,1,0]
  v_cvt_pk_bf16_f32 v88, v94, v95
  v_cvt_pk_bf16_f32 v89, v96, v97
  s_waitcnt lgkmcnt(14)
  ds_write_b64 v49, v[88:89] offset:31232
  s_waitcnt lgkmcnt(0)
  s_barrier
  ds_read_b128 v[140:143], v52 offset:0
  ds_read_b128 v[148:151], v56 offset:0
  ds_read_b128 v[144:147], v52 offset:8192
  ds_read_b128 v[152:155], v60 offset:0
  ds_read_b128 v[160:163], v53 offset:0
  ds_read_b128 v[168:171], v57 offset:0
  buffer_load_dwordx2 v[32:33], v34, s[40:43], 0 offen offset:3072
  ds_read_b128 v[164:167], v53 offset:8192
  ds_read_b128 v[172:175], v61 offset:0
  ds_read_b128 v[180:183], v54 offset:0
  ds_read_b128 v[188:191], v58 offset:0
  ds_read_b128 v[184:187], v54 offset:8192
  ds_read_b128 v[192:195], v62 offset:0
  s_mov_b64 exec, 1
  buffer_load_dwordx2 v[20:21], v35, s[40:43], 0 offen offset:0
  buffer_load_dwordx2 v[22:23], v35, s[40:43], 0 offen offset:1024
  buffer_load_dwordx2 v[24:25], v35, s[40:43], 0 offen offset:2048
  s_mov_b64 exec, -1
  s_waitcnt lgkmcnt(10)
  v_mfma_f32_16x16x32_bf16 v[124:127], v[148:151], v[140:143], 0
  s_waitcnt lgkmcnt(9)
  v_mfma_f32_16x16x32_bf16 v[128:131], v[148:151], v[144:147], 0
  s_waitcnt lgkmcnt(8)
  v_mfma_f32_16x16x32_bf16 v[132:135], v[152:155], v[140:143], 0
  v_mfma_f32_16x16x32_bf16 v[136:139], v[152:155], v[144:147], 0
  ds_read_b128 v[140:143], v55 offset:0
  ds_read_b128 v[148:151], v59 offset:0
  ds_read_b128 v[144:147], v55 offset:8192
  ds_read_b128 v[152:155], v63 offset:0
  s_waitcnt lgkmcnt(10)
  v_mfma_f32_16x16x32_bf16 v[124:127], v[168:171], v[160:163], v[124:127]
  s_waitcnt lgkmcnt(9)
  v_mfma_f32_16x16x32_bf16 v[128:131], v[168:171], v[164:167], v[128:131]
  s_waitcnt lgkmcnt(8)
  v_mfma_f32_16x16x32_bf16 v[132:135], v[172:175], v[160:163], v[132:135]
  v_mfma_f32_16x16x32_bf16 v[136:139], v[172:175], v[164:167], v[136:139]
  ds_read_b128 v[160:163], v52 offset:256
  ds_read_b128 v[168:171], v56 offset:256
  ds_read_b128 v[164:167], v52 offset:8448
  ds_read_b128 v[172:175], v60 offset:256
  s_waitcnt lgkmcnt(10)
  v_mfma_f32_16x16x32_bf16 v[124:127], v[188:191], v[180:183], v[124:127]
  s_waitcnt lgkmcnt(9)
  v_mfma_f32_16x16x32_bf16 v[128:131], v[188:191], v[184:187], v[128:131]
  s_waitcnt lgkmcnt(8)
  v_mfma_f32_16x16x32_bf16 v[132:135], v[192:195], v[180:183], v[132:135]
  v_mfma_f32_16x16x32_bf16 v[136:139], v[192:195], v[184:187], v[136:139]
  ds_read_b128 v[180:183], v53 offset:256
  ds_read_b128 v[188:191], v57 offset:256
  ds_read_b128 v[184:187], v53 offset:8448
  ds_read_b128 v[192:195], v61 offset:256
  s_waitcnt lgkmcnt(10)
  v_mfma_f32_16x16x32_bf16 v[124:127], v[148:151], v[140:143], v[124:127]
  s_waitcnt lgkmcnt(9)
  v_mfma_f32_16x16x32_bf16 v[128:131], v[148:151], v[144:147], v[128:131]
  s_waitcnt lgkmcnt(8)
  v_mfma_f32_16x16x32_bf16 v[132:135], v[152:155], v[140:143], v[132:135]
  v_mfma_f32_16x16x32_bf16 v[136:139], v[152:155], v[144:147], v[136:139]
  ds_read_b128 v[140:143], v54 offset:256
  ds_read_b128 v[148:151], v58 offset:256
  ds_read_b128 v[144:147], v54 offset:8448
  ds_read_b128 v[152:155], v62 offset:256
  s_waitcnt lgkmcnt(10)
  v_mfma_f32_16x16x32_bf16 v[124:127], v[168:171], v[160:163], v[124:127]
  s_waitcnt lgkmcnt(9)
  v_mfma_f32_16x16x32_bf16 v[128:131], v[168:171], v[164:167], v[128:131]
  s_waitcnt lgkmcnt(8)
  v_mfma_f32_16x16x32_bf16 v[132:135], v[172:175], v[160:163], v[132:135]
  v_mfma_f32_16x16x32_bf16 v[136:139], v[172:175], v[164:167], v[136:139]
  ds_read_b128 v[160:163], v55 offset:256
  ds_read_b128 v[168:171], v59 offset:256
  ds_read_b128 v[164:167], v55 offset:8448
  ds_read_b128 v[172:175], v63 offset:256
  s_waitcnt lgkmcnt(10)
  v_mfma_f32_16x16x32_bf16 v[124:127], v[188:191], v[180:183], v[124:127]
  s_waitcnt lgkmcnt(9)
  v_mfma_f32_16x16x32_bf16 v[128:131], v[188:191], v[184:187], v[128:131]
  s_waitcnt lgkmcnt(8)
  v_mfma_f32_16x16x32_bf16 v[132:135], v[192:195], v[180:183], v[132:135]
  v_mfma_f32_16x16x32_bf16 v[136:139], v[192:195], v[184:187], v[136:139]
  s_waitcnt lgkmcnt(6)
  v_mfma_f32_16x16x32_bf16 v[124:127], v[148:151], v[140:143], v[124:127]
  s_waitcnt lgkmcnt(5)
  v_mfma_f32_16x16x32_bf16 v[128:131], v[148:151], v[144:147], v[128:131]
  s_waitcnt lgkmcnt(4)
  v_mfma_f32_16x16x32_bf16 v[132:135], v[152:155], v[140:143], v[132:135]
  v_mfma_f32_16x16x32_bf16 v[136:139], v[152:155], v[144:147], v[136:139]
  s_waitcnt lgkmcnt(2)
  v_mfma_f32_16x16x32_bf16 v[124:127], v[168:171], v[160:163], v[124:127]
  s_waitcnt lgkmcnt(1)
  v_mfma_f32_16x16x32_bf16 v[128:131], v[168:171], v[164:167], v[128:131]
  s_waitcnt lgkmcnt(0)
  v_mfma_f32_16x16x32_bf16 v[132:135], v[172:175], v[160:163], v[132:135]
  v_mfma_f32_16x16x32_bf16 v[136:139], v[172:175], v[164:167], v[136:139]
  s_waitcnt vmcnt(2)
  v_mov_b32_dpp v20, v28 wave_shr:1 row_mask:0xf bank_mask:0xf
  v_mov_b32_dpp v21, v29 wave_shr:1 row_mask:0xf bank_mask:0xf
  s_waitcnt vmcnt(1)
  v_mov_b32_dpp v22, v30 wave_shr:1 row_mask:0xf bank_mask:0xf
  v_mov_b32_dpp v23, v31 wave_shr:1 row_mask:0xf bank_mask:0xf
  s_waitcnt vmcnt(0)
  v_mov_b32_dpp v24, v32 wave_shr:1 row_mask:0xf bank_mask:0xf
  v_mov_b32_dpp v25, v33 wave_shr:1 row_mask:0xf bank_mask:0xf
  s_mov_b32 s72, 0x05040100
  s_mov_b32 s73, 0x07060302
  v_lshrrev_b32 v2, 4, v1
  v_mul_u32_u24 v2, 31744, v2
  v_bfe_u32 v3, v1, 2, 2
  v_mul_u32_u24 v3, 4160, v3
  v_add_u32 v2, v2, v3
  v_and_b32 v3, 3, v1
  v_lshl_add_u32 v201, v3, 4, v2
  v_sub_u32 v202, 511, v0
  v_lshlrev_b32 v202, 3, v202
  v_add_u32 v203, 63488, v202
  v_perm_b32 v204, v24, v26, s72
  v_perm_b32 v205, v20, v22, s72
  v_perm_b32 v206, v26, v28, s72
  v_perm_b32 v207, v22, v24, s72
  v_perm_b32 v208, v28, v30, s72
  v_perm_b32 v209, v24, v26, s72
  v_perm_b32 v210, v30, v32, s72
  v_perm_b32 v211, v26, v28, s72
  v_perm_b32 v212, v24, v26, s73
  v_perm_b32 v213, v20, v22, s73
  v_perm_b32 v214, v26, v28, s73
  v_perm_b32 v215, v22, v24, s73
  v_perm_b32 v216, v28, v30, s73
  v_perm_b32 v217, v24, v26, s73
  v_perm_b32 v218, v30, v32, s73
  v_perm_b32 v219, v26, v28, s73
  v_perm_b32 v220, v25, v27, s72
  v_perm_b32 v221, v21, v23, s72
  v_perm_b32 v222, v27, v29, s72
  v_perm_b32 v223, v23, v25, s72
  v_perm_b32 v224, v29, v31, s72
  v_perm_b32 v225, v25, v27, s72
  v_perm_b32 v226, v31, v33, s72
  v_perm_b32 v227, v27, v29, s72
  v_perm_b32 v228, v25, v27, s73
  v_perm_b32 v229, v21, v23, s73
  v_perm_b32 v230, v27, v29, s73
  v_perm_b32 v231, v23, v25, s73
  v_perm_b32 v232, v29, v31, s73
  v_perm_b32 v233, v25, v27, s73
  v_perm_b32 v234, v31, v33, s73
  v_perm_b32 v235, v27, v29, s73
  s_add_u32 s76, s71, 16640
  v_lshlrev_b32 v4, 5, v1
  v_add_u32 v4, s76, v4
  v_cvt_pk_bf16_f32 v236, v124, v125
  v_cvt_pk_bf16_f32 v237, v126, v127
  v_cvt_pk_bf16_f32 v238, v128, v129
  v_cvt_pk_bf16_f32 v239, v130, v131
  v_cvt_pk_bf16_f32 v240, v132, v133
  v_cvt_pk_bf16_f32 v241, v134, v135
  v_cvt_pk_bf16_f32 v242, v136, v137
  v_cvt_pk_bf16_f32 v243, v138, v139
  v_permlane32_swap_b32 v236, v240
  v_permlane32_swap_b32 v237, v241
  v_permlane32_swap_b32 v238, v242
  v_permlane32_swap_b32 v239, v243
  s_nop 0
  v_permlane16_swap_b32 v236, v238
  v_permlane16_swap_b32 v237, v239
  v_permlane16_swap_b32 v240, v242
  v_permlane16_swap_b32 v241, v243
  s_barrier
  ds_write_b128 v4, v[236:239] offset:2512
  ds_write_b128 v4, v[240:243] offset:2528
  ds_write_b128 v201, v[64:67] offset:4096
  ds_write_b64 v202, v[204:205] offset:0
  ds_write_b64 v202, v[206:207] offset:4160
  ds_write_b64 v202, v[208:209] offset:8320
  ds_write_b64 v202, v[210:211] offset:12480
  ds_write_b64 v202, v[212:213] offset:31744
  ds_write_b64 v202, v[214:215] offset:35904
  ds_write_b64 v202, v[216:217] offset:40064
  ds_write_b64 v202, v[218:219] offset:44224
  ds_write_b64 v203, v[220:221] offset:0
  ds_write_b64 v203, v[222:223] offset:4160
  ds_write_b64 v203, v[224:225] offset:8320
  ds_write_b64 v203, v[226:227] offset:12480
  s_waitcnt lgkmcnt(14)
  ds_write_b64 v203, v[228:229] offset:31744
  s_waitcnt lgkmcnt(14)
  ds_write_b64 v203, v[230:231] offset:35904
  s_waitcnt lgkmcnt(14)
  ds_write_b64 v203, v[232:233] offset:40064
  s_waitcnt lgkmcnt(14)
  ds_write_b64 v203, v[234:235] offset:44224
  v_and_b32 v2, 3, v10
  v_mul_u32_u24 v12, 4160, v2
  v_lshrrev_b32 v2, 2, v10
  v_sub_u32 v2, v11, v2
  v_add_u32 v2, 3, v2
  v_lshl_add_u32 v12, v2, 4, v12
  v_add_u32 v12, s71, v12
  v_lshrrev_b32 v2, 1, v10
  v_lshlrev_b32 v13, 6, v2
  v_lshl_add_u32 v13, v11, 4, v13
  v_and_b32 v2, 1, v10
  v_lshl_add_u32 v13, v2, 3, v13
  v_add3_u32 v13, v13, 8, s76
  s_waitcnt lgkmcnt(0)
  s_barrier
  ds_read_b128 v[48:51], v12 offset:3840
  ds_read_b64 v[80:81], v13 offset:256
  ds_read_b64 v[82:83], v13 offset:264
  ds_read_b128 v[52:55], v12 offset:3328
  ds_read_b64 v[84:85], v13 offset:768
  ds_read_b64 v[86:87], v13 offset:776
  ds_read_b128 v[56:59], v12 offset:2816
  ds_read_b64 v[88:89], v13 offset:1280
  ds_read_b64 v[90:91], v13 offset:1288
  ds_read_b128 v[60:63], v12 offset:2304
  ds_read_b64 v[92:93], v13 offset:1792
  ds_read_b64 v[94:95], v13 offset:1800
  ds_read_b128 v[64:67], v12 offset:1792
  ds_read_b64 v[96:97], v13 offset:2304
  ds_read_b64 v[98:99], v13 offset:2312
  s_waitcnt lgkmcnt(14)
  ds_read_b128 v[68:71], v12 offset:1280
  s_waitcnt lgkmcnt(14)
  ds_read_b64 v[100:101], v13 offset:2816
  s_waitcnt lgkmcnt(14)
  ds_read_b64 v[102:103], v13 offset:2824
  s_waitcnt lgkmcnt(14)
  ds_read_b128 v[72:75], v12 offset:768
  s_waitcnt lgkmcnt(14)
  ds_read_b64 v[104:105], v13 offset:3328
  s_waitcnt lgkmcnt(14)
  ds_read_b64 v[106:107], v13 offset:3336
  s_waitcnt lgkmcnt(14)
  ds_read_b128 v[76:79], v12 offset:256
  s_waitcnt lgkmcnt(14)
  ds_read_b64 v[108:109], v13 offset:3840
  s_waitcnt lgkmcnt(14)
  ds_read_b64 v[110:111], v13 offset:3848
  s_lshl_b32 s78, s35, 4
  s_add_u32 s78, s78, s36
  s_lshl_b32 s78, s78, 2
  s_add_u32 s78, s78, s82
  s_mov_b32 s60, s10
  s_and_b32 s61, s11, 0xffff
  s_mov_b32 s62, 524288
  s_mov_b32 s63, 0x20000
  v_lshrrev_b32 v2, 2, v1
  v_and_b32 v3, 3, v1
  v_lshlrev_b32 v3, 4, v3
  v_lshl_add_u32 v2, v2, 10, v3
  s_and_b32 s64, s78, 31
  s_lshl_b32 s64, s64, 14
  s_lshr_b32 s39, s78, 5
  s_lshl_b32 s39, s39, 6
  s_add_u32 s39, s64, s39
  s_lshl_b32 s64, s82, 10
  s_add_u32 m0, s64, 159744
  s_nop 0
  buffer_load_dwordx4 v2, s[60:63], s39 offen lds
  v_mfma_f32_16x16x32_bf16 v[16:19], v[48:51], v[80:83], 0
  v_mfma_f32_16x16x32_bf16 v[20:23], v[52:55], v[80:83], 0
  s_waitcnt lgkmcnt(14)
  ds_read_b128 v[112:115], v12 offset:3904
  v_mfma_f32_16x16x32_bf16 v[20:23], v[48:51], v[84:87], v[20:23]
  v_mfma_f32_16x16x32_bf16 v[24:27], v[52:55], v[84:87], 0
  s_waitcnt lgkmcnt(14)
  ds_read_b64 v[144:145], v13 offset:320
  v_mfma_f32_16x16x32_bf16 v[24:27], v[56:59], v[80:83], v[24:27]
  s_waitcnt lgkmcnt(14)
  ds_read_b64 v[146:147], v13 offset:328
  v_mfma_f32_16x16x32_bf16 v[28:31], v[56:59], v[84:87], 0
  v_mfma_f32_16x16x32_bf16 v[24:27], v[48:51], v[88:91], v[24:27]
  s_waitcnt lgkmcnt(14)
  ds_read_b128 v[116:119], v12 offset:3392
  v_mfma_f32_16x16x32_bf16 v[28:31], v[52:55], v[88:91], v[28:31]
  s_waitcnt lgkmcnt(14)
  ds_read_b64 v[148:149], v13 offset:832
  v_mfma_f32_16x16x32_bf16 v[32:35], v[56:59], v[88:91], 0
  v_mfma_f32_16x16x32_bf16 v[28:31], v[60:63], v[80:83], v[28:31]
  s_waitcnt lgkmcnt(14)
  ds_read_b64 v[150:151], v13 offset:840
  v_mfma_f32_16x16x32_bf16 v[32:35], v[60:63], v[84:87], v[32:35]
  s_waitcnt lgkmcnt(14)
  ds_read_b128 v[120:123], v12 offset:2880
  v_mfma_f32_16x16x32_bf16 v[36:39], v[60:63], v[88:91], 0
  v_mfma_f32_16x16x32_bf16 v[28:31], v[48:51], v[92:95], v[28:31]
  s_waitcnt lgkmcnt(14)
  ds_read_b64 v[152:153], v13 offset:1344
  v_mfma_f32_16x16x32_bf16 v[32:35], v[52:55], v[92:95], v[32:35]
  s_waitcnt lgkmcnt(14)
  ds_read_b64 v[154:155], v13 offset:1352
  v_mfma_f32_16x16x32_bf16 v[36:39], v[56:59], v[92:95], v[36:39]
  v_mfma_f32_16x16x32_bf16 v[40:43], v[60:63], v[92:95], 0
  s_waitcnt lgkmcnt(14)
  ds_read_b128 v[124:127], v12 offset:2368
  v_mfma_f32_16x16x32_bf16 v[32:35], v[64:67], v[80:83], v[32:35]
  s_waitcnt lgkmcnt(14)
  ds_read_b64 v[156:157], v13 offset:1856
  v_mfma_f32_16x16x32_bf16 v[36:39], v[64:67], v[84:87], v[36:39]
  v_mfma_f32_16x16x32_bf16 v[40:43], v[64:67], v[88:91], v[40:43]
  s_waitcnt lgkmcnt(14)
  ds_read_b64 v[158:159], v13 offset:1864
  v_mfma_f32_16x16x32_bf16 v[44:47], v[64:67], v[92:95], 0
  s_waitcnt lgkmcnt(14)
  ds_read_b128 v[128:131], v12 offset:1856
  v_mfma_f32_16x16x32_bf16 v[32:35], v[48:51], v[96:99], v[32:35]
  v_mfma_f32_16x16x32_bf16 v[36:39], v[52:55], v[96:99], v[36:39]
  s_waitcnt lgkmcnt(14)
  ds_read_b64 v[160:161], v13 offset:2368
  v_mfma_f32_16x16x32_bf16 v[40:43], v[56:59], v[96:99], v[40:43]
  s_waitcnt lgkmcnt(14)
  ds_read_b64 v[162:163], v13 offset:2376
  v_mfma_f32_16x16x32_bf16 v[44:47], v[60:63], v[96:99], v[44:47]
  v_mfma_f32_16x16x32_bf16 v[36:39], v[68:71], v[80:83], v[36:39]
  s_waitcnt lgkmcnt(14)
  ds_read_b128 v[132:135], v12 offset:1344
  v_mfma_f32_16x16x32_bf16 v[40:43], v[68:71], v[84:87], v[40:43]
  s_waitcnt lgkmcnt(14)
  ds_read_b64 v[164:165], v13 offset:2880
  v_mfma_f32_16x16x32_bf16 v[44:47], v[68:71], v[88:91], v[44:47]
  v_mfma_f32_16x16x32_bf16 v[36:39], v[48:51], v[100:103], v[36:39]
  s_waitcnt lgkmcnt(14)
  ds_read_b64 v[166:167], v13 offset:2888
  v_mfma_f32_16x16x32_bf16 v[40:43], v[52:55], v[100:103], v[40:43]
  s_waitcnt lgkmcnt(14)
  ds_read_b128 v[136:139], v12 offset:832
  v_mfma_f32_16x16x32_bf16 v[44:47], v[56:59], v[100:103], v[44:47]
  v_mfma_f32_16x16x32_bf16 v[40:43], v[72:75], v[80:83], v[40:43]
  s_waitcnt lgkmcnt(14)
  ds_read_b64 v[168:169], v13 offset:3392
  v_mfma_f32_16x16x32_bf16 v[44:47], v[72:75], v[84:87], v[44:47]
  s_waitcnt lgkmcnt(14)
  ds_read_b64 v[170:171], v13 offset:3400
  v_mfma_f32_16x16x32_bf16 v[40:43], v[48:51], v[104:107], v[40:43]
  v_mfma_f32_16x16x32_bf16 v[44:47], v[52:55], v[104:107], v[44:47]
  s_waitcnt lgkmcnt(14)
  ds_read_b128 v[140:143], v12 offset:320
  v_mfma_f32_16x16x32_bf16 v[44:47], v[76:79], v[80:83], v[44:47]
  s_waitcnt lgkmcnt(14)
  ds_read_b64 v[172:173], v13 offset:3904
  v_mfma_f32_16x16x32_bf16 v[44:47], v[48:51], v[108:111], v[44:47]
  s_waitcnt lgkmcnt(14)
  ds_read_b64 v[174:175], v13 offset:3912
  v_mfma_f32_16x16x32_bf16 v[16:19], v[112:115], v[144:147], v[16:19]
  v_mfma_f32_16x16x32_bf16 v[20:23], v[116:119], v[144:147], v[20:23]
  s_waitcnt lgkmcnt(14)
  ds_read_b128 v[48:51], v12 offset:3968
  v_mfma_f32_16x16x32_bf16 v[20:23], v[112:115], v[148:151], v[20:23]
  v_mfma_f32_16x16x32_bf16 v[24:27], v[116:119], v[148:151], v[24:27]
  s_waitcnt lgkmcnt(14)
  ds_read_b64 v[80:81], v13 offset:384
  v_mfma_f32_16x16x32_bf16 v[24:27], v[120:123], v[144:147], v[24:27]
  s_waitcnt lgkmcnt(14)
  ds_read_b64 v[82:83], v13 offset:392
  v_mfma_f32_16x16x32_bf16 v[28:31], v[120:123], v[148:151], v[28:31]
  v_mfma_f32_16x16x32_bf16 v[24:27], v[112:115], v[152:155], v[24:27]
  s_waitcnt lgkmcnt(14)
  ds_read_b128 v[52:55], v12 offset:3456
  v_mfma_f32_16x16x32_bf16 v[28:31], v[116:119], v[152:155], v[28:31]
  s_waitcnt lgkmcnt(14)
  ds_read_b64 v[84:85], v13 offset:896
  v_mfma_f32_16x16x32_bf16 v[32:35], v[120:123], v[152:155], v[32:35]
  v_mfma_f32_16x16x32_bf16 v[28:31], v[124:127], v[144:147], v[28:31]
  s_waitcnt lgkmcnt(14)
  ds_read_b64 v[86:87], v13 offset:904
  v_mfma_f32_16x16x32_bf16 v[32:35], v[124:127], v[148:151], v[32:35]
  s_waitcnt lgkmcnt(14)
  ds_read_b128 v[56:59], v12 offset:2944
  v_mfma_f32_16x16x32_bf16 v[36:39], v[124:127], v[152:155], v[36:39]
  v_mfma_f32_16x16x32_bf16 v[28:31], v[112:115], v[156:159], v[28:31]
  s_waitcnt lgkmcnt(14)
  ds_read_b64 v[88:89], v13 offset:1408
  v_mfma_f32_16x16x32_bf16 v[32:35], v[116:119], v[156:159], v[32:35]
  s_waitcnt lgkmcnt(14)
  ds_read_b64 v[90:91], v13 offset:1416
  v_mfma_f32_16x16x32_bf16 v[36:39], v[120:123], v[156:159], v[36:39]
  v_mfma_f32_16x16x32_bf16 v[40:43], v[124:127], v[156:159], v[40:43]
  s_waitcnt lgkmcnt(14)
  ds_read_b128 v[60:63], v12 offset:2432
  v_mfma_f32_16x16x32_bf16 v[32:35], v[128:131], v[144:147], v[32:35]
  s_waitcnt lgkmcnt(14)
  ds_read_b64 v[92:93], v13 offset:1920
  v_mfma_f32_16x16x32_bf16 v[36:39], v[128:131], v[148:151], v[36:39]
  v_mfma_f32_16x16x32_bf16 v[40:43], v[128:131], v[152:155], v[40:43]
  s_waitcnt lgkmcnt(14)
  ds_read_b64 v[94:95], v13 offset:1928
  v_mfma_f32_16x16x32_bf16 v[44:47], v[128:131], v[156:159], v[44:47]
  s_waitcnt lgkmcnt(14)
  ds_read_b128 v[64:67], v12 offset:1920
  v_mfma_f32_16x16x32_bf16 v[32:35], v[112:115], v[160:163], v[32:35]
  v_mfma_f32_16x16x32_bf16 v[36:39], v[116:119], v[160:163], v[36:39]
  s_waitcnt lgkmcnt(14)
  ds_read_b64 v[96:97], v13 offset:2432
  v_mfma_f32_16x16x32_bf16 v[40:43], v[120:123], v[160:163], v[40:43]
  s_waitcnt lgkmcnt(14)
  ds_read_b64 v[98:99], v13 offset:2440
  v_mfma_f32_16x16x32_bf16 v[44:47], v[124:127], v[160:163], v[44:47]
  v_mfma_f32_16x16x32_bf16 v[36:39], v[132:135], v[144:147], v[36:39]
  s_waitcnt lgkmcnt(14)
  ds_read_b128 v[68:71], v12 offset:1408
  v_mfma_f32_16x16x32_bf16 v[40:43], v[132:135], v[148:151], v[40:43]
  s_waitcnt lgkmcnt(14)
  ds_read_b64 v[100:101], v13 offset:2944
  v_mfma_f32_16x16x32_bf16 v[44:47], v[132:135], v[152:155], v[44:47]
  v_mfma_f32_16x16x32_bf16 v[36:39], v[112:115], v[164:167], v[36:39]
  s_waitcnt lgkmcnt(14)
  ds_read_b64 v[102:103], v13 offset:2952
  v_mfma_f32_16x16x32_bf16 v[40:43], v[116:119], v[164:167], v[40:43]
  s_waitcnt lgkmcnt(14)
  ds_read_b128 v[72:75], v12 offset:896
  v_mfma_f32_16x16x32_bf16 v[44:47], v[120:123], v[164:167], v[44:47]
  v_mfma_f32_16x16x32_bf16 v[40:43], v[136:139], v[144:147], v[40:43]
  s_waitcnt lgkmcnt(14)
  ds_read_b64 v[104:105], v13 offset:3456
  v_mfma_f32_16x16x32_bf16 v[44:47], v[136:139], v[148:151], v[44:47]
  s_waitcnt lgkmcnt(14)
  ds_read_b64 v[106:107], v13 offset:3464
  v_mfma_f32_16x16x32_bf16 v[40:43], v[112:115], v[168:171], v[40:43]
  v_mfma_f32_16x16x32_bf16 v[44:47], v[116:119], v[168:171], v[44:47]
  s_waitcnt lgkmcnt(14)
  ds_read_b128 v[76:79], v12 offset:384
  v_mfma_f32_16x16x32_bf16 v[44:47], v[140:143], v[144:147], v[44:47]
  s_waitcnt lgkmcnt(14)
  ds_read_b64 v[108:109], v13 offset:3968
  v_mfma_f32_16x16x32_bf16 v[44:47], v[112:115], v[172:175], v[44:47]
  s_waitcnt lgkmcnt(14)
  ds_read_b64 v[110:111], v13 offset:3976
  v_mfma_f32_16x16x32_bf16 v[16:19], v[48:51], v[80:83], v[16:19]
  v_mfma_f32_16x16x32_bf16 v[20:23], v[52:55], v[80:83], v[20:23]
  s_waitcnt lgkmcnt(14)
  ds_read_b128 v[112:115], v12 offset:4032
  v_mfma_f32_16x16x32_bf16 v[20:23], v[48:51], v[84:87], v[20:23]
  v_mfma_f32_16x16x32_bf16 v[24:27], v[52:55], v[84:87], v[24:27]
  s_waitcnt lgkmcnt(14)
  ds_read_b64 v[144:145], v13 offset:448
  v_mfma_f32_16x16x32_bf16 v[24:27], v[56:59], v[80:83], v[24:27]
  s_waitcnt lgkmcnt(14)
  ds_read_b64 v[146:147], v13 offset:456
  v_mfma_f32_16x16x32_bf16 v[28:31], v[56:59], v[84:87], v[28:31]
  v_mfma_f32_16x16x32_bf16 v[24:27], v[48:51], v[88:91], v[24:27]
  s_waitcnt lgkmcnt(14)
  ds_read_b128 v[116:119], v12 offset:3520
  v_mfma_f32_16x16x32_bf16 v[28:31], v[52:55], v[88:91], v[28:31]
  s_waitcnt lgkmcnt(14)
  ds_read_b64 v[148:149], v13 offset:960
  v_mfma_f32_16x16x32_bf16 v[32:35], v[56:59], v[88:91], v[32:35]
  v_mfma_f32_16x16x32_bf16 v[28:31], v[60:63], v[80:83], v[28:31]
  s_waitcnt lgkmcnt(14)
  ds_read_b64 v[150:151], v13 offset:968
  v_mfma_f32_16x16x32_bf16 v[32:35], v[60:63], v[84:87], v[32:35]
  s_waitcnt lgkmcnt(14)
  ds_read_b128 v[120:123], v12 offset:3008
  v_mfma_f32_16x16x32_bf16 v[36:39], v[60:63], v[88:91], v[36:39]
  v_mfma_f32_16x16x32_bf16 v[28:31], v[48:51], v[92:95], v[28:31]
  s_waitcnt lgkmcnt(14)
  ds_read_b64 v[152:153], v13 offset:1472
  v_mfma_f32_16x16x32_bf16 v[32:35], v[52:55], v[92:95], v[32:35]
  s_waitcnt lgkmcnt(14)
  ds_read_b64 v[154:155], v13 offset:1480
  v_mfma_f32_16x16x32_bf16 v[36:39], v[56:59], v[92:95], v[36:39]
  v_mfma_f32_16x16x32_bf16 v[40:43], v[60:63], v[92:95], v[40:43]
  s_waitcnt lgkmcnt(14)
  ds_read_b128 v[124:127], v12 offset:2496
  v_mfma_f32_16x16x32_bf16 v[32:35], v[64:67], v[80:83], v[32:35]
  s_waitcnt lgkmcnt(14)
  ds_read_b64 v[156:157], v13 offset:1984
  v_mfma_f32_16x16x32_bf16 v[36:39], v[64:67], v[84:87], v[36:39]
  v_mfma_f32_16x16x32_bf16 v[40:43], v[64:67], v[88:91], v[40:43]
  s_waitcnt lgkmcnt(14)
  ds_read_b64 v[158:159], v13 offset:1992
  v_mfma_f32_16x16x32_bf16 v[44:47], v[64:67], v[92:95], v[44:47]
  s_waitcnt lgkmcnt(14)
  ds_read_b128 v[128:131], v12 offset:1984
  v_mfma_f32_16x16x32_bf16 v[32:35], v[48:51], v[96:99], v[32:35]
  v_mfma_f32_16x16x32_bf16 v[36:39], v[52:55], v[96:99], v[36:39]
  s_waitcnt lgkmcnt(14)
  ds_read_b64 v[160:161], v13 offset:2496
  v_mfma_f32_16x16x32_bf16 v[40:43], v[56:59], v[96:99], v[40:43]
  s_waitcnt lgkmcnt(14)
  ds_read_b64 v[162:163], v13 offset:2504
  v_mfma_f32_16x16x32_bf16 v[44:47], v[60:63], v[96:99], v[44:47]
  v_mfma_f32_16x16x32_bf16 v[36:39], v[68:71], v[80:83], v[36:39]
  s_waitcnt lgkmcnt(14)
  ds_read_b128 v[132:135], v12 offset:1472
  v_mfma_f32_16x16x32_bf16 v[40:43], v[68:71], v[84:87], v[40:43]
  s_waitcnt lgkmcnt(14)
  ds_read_b64 v[164:165], v13 offset:3008
  v_mfma_f32_16x16x32_bf16 v[44:47], v[68:71], v[88:91], v[44:47]
  v_mfma_f32_16x16x32_bf16 v[36:39], v[48:51], v[100:103], v[36:39]
  s_waitcnt lgkmcnt(14)
  ds_read_b64 v[166:167], v13 offset:3016
  v_mfma_f32_16x16x32_bf16 v[40:43], v[52:55], v[100:103], v[40:43]
  s_waitcnt lgkmcnt(14)
  ds_read_b128 v[136:139], v12 offset:960
  v_mfma_f32_16x16x32_bf16 v[44:47], v[56:59], v[100:103], v[44:47]
  v_mfma_f32_16x16x32_bf16 v[40:43], v[72:75], v[80:83], v[40:43]
  s_waitcnt lgkmcnt(14)
  ds_read_b64 v[168:169], v13 offset:3520
  v_mfma_f32_16x16x32_bf16 v[44:47], v[72:75], v[84:87], v[44:47]
  s_waitcnt lgkmcnt(14)
  ds_read_b64 v[170:171], v13 offset:3528
  v_mfma_f32_16x16x32_bf16 v[40:43], v[48:51], v[104:107], v[40:43]
  v_mfma_f32_16x16x32_bf16 v[44:47], v[52:55], v[104:107], v[44:47]
  s_waitcnt lgkmcnt(14)
  ds_read_b128 v[140:143], v12 offset:448
  v_mfma_f32_16x16x32_bf16 v[44:47], v[76:79], v[80:83], v[44:47]
  s_waitcnt lgkmcnt(14)
  ds_read_b64 v[172:173], v13 offset:4032
  v_mfma_f32_16x16x32_bf16 v[44:47], v[48:51], v[108:111], v[44:47]
  s_waitcnt lgkmcnt(14)
  ds_read_b64 v[174:175], v13 offset:4040
  v_bfe_u32 v2, v1, 2, 2
  v_lshrrev_b32 v3, 5, v1
  v_lshl_add_u32 v2, v3, 2, v2
  v_lshlrev_b32 v180, 6, v2
  v_bfe_u32 v3, v1, 4, 1
  v_lshl_add_u32 v180, v3, 5, v180
  v_and_b32 v3, 3, v1
  v_lshl_add_u32 v180, v3, 3, v180
  s_lshl_b32 s64, s82, 10
  s_add_u32 s64, s64, 159744
  v_add_u32 v180, s64, v180
  s_waitcnt vmcnt(0)
  s_waitcnt lgkmcnt(14)
  ds_read_b64_tr_b16 v[176:177], v180
  s_waitcnt lgkmcnt(14)
  ds_read_b64_tr_b16 v[178:179], v180 offset:512
  v_lshlrev_b32 v2, 4, v1
  s_lshl_b32 s64, s78, 10
  s_add_u32 s64, s64, 6291456
  s_waitcnt lgkmcnt(0)
  buffer_store_dwordx4 v[176:179], v2, s[48:51], s64 offen sc1
  v_mfma_f32_16x16x32_bf16 v[16:19], v[112:115], v[144:147], v[16:19]
  v_mfma_f32_16x16x32_bf16 v[20:23], v[116:119], v[144:147], v[20:23]
  v_mfma_f32_16x16x32_bf16 v[20:23], v[112:115], v[148:151], v[20:23]
  v_mfma_f32_16x16x32_bf16 v[24:27], v[116:119], v[148:151], v[24:27]
  v_mfma_f32_16x16x32_bf16 v[24:27], v[120:123], v[144:147], v[24:27]
  v_mfma_f32_16x16x32_bf16 v[28:31], v[120:123], v[148:151], v[28:31]
  v_mfma_f32_16x16x32_bf16 v[24:27], v[112:115], v[152:155], v[24:27]
  v_mfma_f32_16x16x32_bf16 v[28:31], v[116:119], v[152:155], v[28:31]
  v_mfma_f32_16x16x32_bf16 v[32:35], v[120:123], v[152:155], v[32:35]
  v_mfma_f32_16x16x32_bf16 v[28:31], v[124:127], v[144:147], v[28:31]
  v_mfma_f32_16x16x32_bf16 v[32:35], v[124:127], v[148:151], v[32:35]
  v_mfma_f32_16x16x32_bf16 v[36:39], v[124:127], v[152:155], v[36:39]
  v_mfma_f32_16x16x32_bf16 v[28:31], v[112:115], v[156:159], v[28:31]
  v_mfma_f32_16x16x32_bf16 v[32:35], v[116:119], v[156:159], v[32:35]
  v_mfma_f32_16x16x32_bf16 v[36:39], v[120:123], v[156:159], v[36:39]
  v_mfma_f32_16x16x32_bf16 v[40:43], v[124:127], v[156:159], v[40:43]
  v_mfma_f32_16x16x32_bf16 v[32:35], v[128:131], v[144:147], v[32:35]
  v_mfma_f32_16x16x32_bf16 v[36:39], v[128:131], v[148:151], v[36:39]
  v_mfma_f32_16x16x32_bf16 v[40:43], v[128:131], v[152:155], v[40:43]
  v_mfma_f32_16x16x32_bf16 v[44:47], v[128:131], v[156:159], v[44:47]
  v_mfma_f32_16x16x32_bf16 v[32:35], v[112:115], v[160:163], v[32:35]
  v_mfma_f32_16x16x32_bf16 v[36:39], v[116:119], v[160:163], v[36:39]
  v_mfma_f32_16x16x32_bf16 v[40:43], v[120:123], v[160:163], v[40:43]
  v_mfma_f32_16x16x32_bf16 v[44:47], v[124:127], v[160:163], v[44:47]
  v_mfma_f32_16x16x32_bf16 v[36:39], v[132:135], v[144:147], v[36:39]
  v_mfma_f32_16x16x32_bf16 v[40:43], v[132:135], v[148:151], v[40:43]
  v_mfma_f32_16x16x32_bf16 v[44:47], v[132:135], v[152:155], v[44:47]
  v_mfma_f32_16x16x32_bf16 v[36:39], v[112:115], v[164:167], v[36:39]
  v_mfma_f32_16x16x32_bf16 v[40:43], v[116:119], v[164:167], v[40:43]
  v_mfma_f32_16x16x32_bf16 v[44:47], v[120:123], v[164:167], v[44:47]
  v_mfma_f32_16x16x32_bf16 v[40:43], v[136:139], v[144:147], v[40:43]
  v_mfma_f32_16x16x32_bf16 v[44:47], v[136:139], v[148:151], v[44:47]
  v_mfma_f32_16x16x32_bf16 v[40:43], v[112:115], v[168:171], v[40:43]
  v_mfma_f32_16x16x32_bf16 v[44:47], v[116:119], v[168:171], v[44:47]
  v_mfma_f32_16x16x32_bf16 v[44:47], v[140:143], v[144:147], v[44:47]
  v_mfma_f32_16x16x32_bf16 v[44:47], v[112:115], v[172:175], v[44:47]
  v_lshlrev_b32 v2, 4, v1
  s_lshl_b32 s64, s34, 12
  s_add_u32 s64, s64, 126976
  v_add_u32 v4, s64, v2
  s_xor_b32 s65, s34, 1
  s_lshl_b32 s65, s65, 12
  s_add_u32 s65, s65, 126976
  v_add_u32 v12, s65, v2
  ds_write_b128 v4, v[16:19] offset:0
  ds_write_b128 v4, v[20:23] offset:1024
  ds_write_b128 v4, v[24:27] offset:2048
  ds_write_b128 v4, v[28:31] offset:3072
  v_lshrrev_b32 v2, 1, v10
  v_lshlrev_b32 v13, 6, v2
  v_lshl_add_u32 v13, v11, 4, v13
  v_and_b32 v2, 1, v10
  v_lshl_add_u32 v13, v2, 3, v13
  s_add_u32 s64, s66, s67
  s_lshl_b32 s64, s64, 12
  s_add_u32 s64, s64, 4196352
  s_waitcnt lgkmcnt(0)
  s_barrier
  ds_read_b128 v[48:51], v12 offset:0
  ds_read_b128 v[52:55], v12 offset:1024
  ds_read_b128 v[56:59], v12 offset:2048
  ds_read_b128 v[60:63], v12 offset:3072
  s_waitcnt lgkmcnt(3)
  v_pk_add_f32 v[48:49], v[48:49], v[32:33]
  v_pk_add_f32 v[50:51], v[50:51], v[34:35]
  v_cvt_pk_bf16_f32 v48, v48, v49
  v_cvt_pk_bf16_f32 v49, v50, v51
  buffer_store_dwordx2 v[48:49], v13, s[48:51], s64 offen offset:0 sc1
  s_waitcnt lgkmcnt(2)
  v_pk_add_f32 v[52:53], v[52:53], v[36:37]
  v_pk_add_f32 v[54:55], v[54:55], v[38:39]
  v_cvt_pk_bf16_f32 v52, v52, v53
  v_cvt_pk_bf16_f32 v53, v54, v55
  buffer_store_dwordx2 v[52:53], v13, s[48:51], s64 offen offset:512 sc1
  s_waitcnt lgkmcnt(1)
  v_pk_add_f32 v[56:57], v[56:57], v[40:41]
  v_pk_add_f32 v[58:59], v[58:59], v[42:43]
  v_cvt_pk_bf16_f32 v56, v56, v57
  v_cvt_pk_bf16_f32 v57, v58, v59
  buffer_store_dwordx2 v[56:57], v13, s[48:51], s64 offen offset:1024 sc1
  s_waitcnt lgkmcnt(0)
  v_pk_add_f32 v[60:61], v[60:61], v[44:45]
  v_pk_add_f32 v[62:63], v[62:63], v[46:47]
  v_cvt_pk_bf16_f32 v60, v60, v61
  v_cvt_pk_bf16_f32 v61, v62, v63
  buffer_store_dwordx2 v[60:61], v13, s[48:51], s64 offen offset:1536 sc1
  s_endpgm
L_mix_kernel_end:
  s_endpgm

.section .rodata,"a"
.p2align 6
.amdhsa_kernel mix_kernel
  .amdhsa_next_free_vgpr 256
  .amdhsa_next_free_sgpr 96
  .amdhsa_accum_offset 256
  .amdhsa_group_segment_fixed_size 0
  .amdhsa_kernarg_size 120
  .amdhsa_user_sgpr_count 2
  .amdhsa_user_sgpr_kernarg_segment_ptr 1
  .amdhsa_system_sgpr_workgroup_id_x 1
.end_amdhsa_kernel
.text
.globl fin_kernel
.p2align 8
.type fin_kernel,@function
fin_kernel:
  s_cmp_ge_u32 s2, 256
  s_cbranch_scc1 L_fin_kernel_end
  s_load_dwordx2 s[4:5], s[0:1], 96
  s_load_dwordx2 s[6:7], s[0:1], 112
  v_lshrrev_b32 v13, 6, v0
  v_and_b32 v1, 63, v0
  v_readfirstlane_b32 s16, v13
  v_and_b32 v2, 31, v1
  v_lshrrev_b32 v3, 5, v1
  v_lshlrev_b32 v4, 4, v1
  s_and_b32 s20, s2, 7
  s_lshr_b32 s21, s2, 5
  s_lshr_b32 s18, s2, 3
  s_and_b32 s18, s18, 3
  s_and_b32 s19, s20, 3
  s_lshl_b32 s19, s19, 4
  s_lshr_b32 s20, s20, 2
  s_lshl_b32 s20, s20, 3
  s_add_u32 s17, s19, s20
  s_add_u32 s17, s17, s21
  v_lshlrev_b32 v13, 4, v2
  v_lshl_add_u32 v13, v3, 8, v13
  v_lshlrev_b32 v14, 4, v3
  v_add_u32 v14, 2048, v14
  v_cmp_gt_u32 vcc, 16, v2
  s_nop 1
  v_cndmask_b32 v6, v14, v13, vcc
  v_mov_b32 v13, 512
  v_mov_b32 v14, 32
  v_cndmask_b32 v13, v14, v13, vcc
  v_add_u32 v7, v6, v13
  v_add_u32 v8, v7, v13
  v_add_u32 v9, v8, v13
  s_lshl_b32 s20, s17, 16
  s_lshl_b32 s21, s16, 14
  s_add_u32 s22, s20, s21
  s_mul_i32 s23, s16, 17408
  s_add_u32 s23, s23, 6815744
  s_lshl_b32 s20, s18, 2
  s_add_u32 s20, s20, s16
  s_lshl_b32 s24, s20, 15
  s_add_u32 s24, s24, 6291456
  s_lshl_b32 s25, s20, 17
  s_lshl_b32 s21, s17, 6
  s_add_u32 s25, s25, s21
  s_add_u32 s25, s25, 4194304
  s_lshl_b32 s21, s17, 7
  s_add_u32 s26, s21, 6946816
  s_lshl_b32 s27, s17, 15
  s_lshl_b32 s21, s20, 6
  s_add_u32 s27, s27, s21
  s_waitcnt lgkmcnt(0)
  s_mov_b32 s8, s6
  s_and_b32 s9, s7, 0xffff
  s_mov_b32 s10, 8388608
  s_mov_b32 s11, 0x20000
  s_mul_i32 s28, s16, 17408
  s_add_u32 s28, s28, 32768
  v_add_u32 v6, s28, v6
  v_add_u32 v7, s28, v7
  v_add_u32 v8, s28, v8
  v_add_u32 v9, s28, v9
  s_add_u32 m0, s28, 0
  s_add_u32 s33, s23, 0
  buffer_load_dwordx4 v4, s[8:11], s33 offen lds
  s_add_u32 m0, s28, 1024
  s_add_u32 s33, s23, 1024
  buffer_load_dwordx4 v4, s[8:11], s33 offen lds
  s_add_u32 m0, s28, 2048
  s_add_u32 s33, s23, 2048
  buffer_load_dwordx4 v4, s[8:11], s33 offen lds
  s_add_u32 s33, s22, 0
  buffer_load_dwordx4 v[16:19], v4, s[8:11], s33 offen
  s_add_u32 s33, s22, 1024
  buffer_load_dwordx4 v[20:23], v4, s[8:11], s33 offen
  s_add_u32 m0, s28, 3072
  s_add_u32 s33, s23, 3072
  buffer_load_dwordx4 v4, s[8:11], s33 offen lds
  s_add_u32 m0, s28, 4096
  s_add_u32 s33, s23, 4096
  buffer_load_dwordx4 v4, s[8:11], s33 offen lds
  s_add_u32 s33, s22, 2048
  buffer_load_dwordx4 v[24:27], v4, s[8:11], s33 offen
  s_add_u32 s33, s22, 3072
  buffer_load_dwordx4 v[28:31], v4, s[8:11], s33 offen
  s_add_u32 m0, s28, 5120
  s_add_u32 s33, s23, 5120
  buffer_load_dwordx4 v4, s[8:11], s33 offen lds
  s_add_u32 m0, s28, 6144
  s_add_u32 s33, s23, 6144
  buffer_load_dwordx4 v4, s[8:11], s33 offen lds
  s_add_u32 s33, s22, 4096
  buffer_load_dwordx4 v[32:35], v4, s[8:11], s33 offen
  s_add_u32 s33, s22, 5120
  buffer_load_dwordx4 v[36:39], v4, s[8:11], s33 offen
  s_add_u32 s33, s24, 0
  buffer_load_dwordx4 a[0:3], v4, s[8:11], s33 offen
  s_add_u32 s33, s24, 1024
  buffer_load_dwordx4 a[4:7], v4, s[8:11], s33 offen
  s_add_u32 s33, s24, 8192
  buffer_load_dwordx4 a[32:35], v4, s[8:11], s33 offen
  s_add_u32 s33, s24, 9216
  buffer_load_dwordx4 a[36:39], v4, s[8:11], s33 offen
  s_add_u32 m0, s28, 7168
  s_add_u32 s33, s23, 7168
  buffer_load_dwordx4 v4, s[8:11], s33 offen lds
  s_add_u32 m0, s28, 8192
  s_add_u32 s33, s23, 8192
  buffer_load_dwordx4 v4, s[8:11], s33 offen lds
  s_add_u32 s33, s22, 6144
  buffer_load_dwordx4 v[40:43], v4, s[8:11], s33 offen
  v_lshrrev_b32 v10, 2, v1
  v_lshlrev_b32 v10, 12, v10
  v_and_b32 v13, 3, v1
  v_lshl_add_u32 v10, v13, 4, v10
  v_lshlrev_b32 v11, 2, v2
  v_lshlrev_b32 v12, 10, v2
  v_lshl_add_u32 v12, v3, 4, v12
  s_lshl_b32 s34, s16, 11
  s_add_u32 s34, s34, 102400
  v_bfe_u32 v13, v1, 2, 2
  v_lshl_add_u32 v13, v3, 2, v13
  v_lshlrev_b32 v137, 6, v13
  v_bfe_u32 v13, v1, 4, 1
  v_lshl_add_u32 v137, v13, 5, v137
  v_and_b32 v13, 3, v1
  v_lshl_add_u32 v137, v13, 3, v137
  v_add_u32 v137, s34, v137
  s_mov_b32 s12, s4
  s_and_b32 s13, s5, 0xffff
  s_mov_b32 s14, 2097152
  s_mov_b32 s15, 0x20000
  s_lshl_b32 s20, s16, 13
  v_add_u32 v138, s20, v4
  s_waitcnt vmcnt(17)
  ds_read_b128 v[80:83], v6 offset:0
  ds_read_b128 v[84:87], v7 offset:0
  ds_read_b128 v[88:91], v8 offset:0
  ds_read_b128 v[92:95], v9 offset:0
  s_waitcnt vmcnt(13)
  ds_read_b128 v[96:99], v6 offset:2176
  ds_read_b128 v[100:103], v7 offset:2176
  ds_read_b128 v[104:107], v8 offset:2176
  ds_read_b128 v[108:111], v9 offset:2176
  s_add_u32 s33, s22, 7168
  buffer_load_dwordx4 v[44:47], v4, s[8:11], s33 offen
  s_waitcnt lgkmcnt(7)
  v_cvt_pk_bf16_f32 v80, v80, v81
  v_cvt_pk_bf16_f32 v81, v82, v83
  s_waitcnt lgkmcnt(6)
  v_cvt_pk_bf16_f32 v82, v84, v85
  v_cvt_pk_bf16_f32 v83, v86, v87
  s_waitcnt lgkmcnt(5)
  v_cvt_pk_bf16_f32 v84, v88, v89
  v_cvt_pk_bf16_f32 v85, v90, v91
  s_waitcnt lgkmcnt(4)
  v_cvt_pk_bf16_f32 v86, v92, v93
  v_cvt_pk_bf16_f32 v87, v94, v95
  s_add_u32 s33, s24, 16384
  buffer_load_dwordx4 a[64:67], v4, s[8:11], s33 offen
  v_mfma_f32_32x32x16_bf16 v[140:155], v[80:83], v[16:19], 0
  v_mfma_f32_32x32x16_bf16 v[140:155], v[84:87], v[20:23], v[140:155]
  s_add_u32 s33, s24, 17408
  buffer_load_dwordx4 a[68:71], v4, s[8:11], s33 offen
  s_waitcnt lgkmcnt(3)
  v_cvt_pk_bf16_f32 v96, v96, v97
  v_cvt_pk_bf16_f32 v97, v98, v99
  s_waitcnt lgkmcnt(2)
  v_cvt_pk_bf16_f32 v98, v100, v101
  v_cvt_pk_bf16_f32 v99, v102, v103
  s_waitcnt lgkmcnt(1)
  v_cvt_pk_bf16_f32 v100, v104, v105
  v_cvt_pk_bf16_f32 v101, v106, v107
  s_waitcnt lgkmcnt(0)
  v_cvt_pk_bf16_f32 v102, v108, v109
  v_cvt_pk_bf16_f32 v103, v110, v111
  s_add_u32 s33, s24, 24576
  buffer_load_dwordx4 a[96:99], v4, s[8:11], s33 offen
  s_waitcnt vmcnt(16)
  v_mfma_f32_32x32x16_bf16 v[156:171], v[96:99], v[24:27], 0
  s_waitcnt vmcnt(15)
  v_mfma_f32_32x32x16_bf16 v[156:171], v[100:103], v[28:31], v[156:171]
  s_add_u32 s33, s24, 25600
  buffer_load_dwordx4 a[100:103], v4, s[8:11], s33 offen
  v_add_f32 v13, 0x358637bd, v148
  v_rcp_f32 v13, v13
  s_nop 0
  v_mul_f32 v140, v140, v13
  v_mul_f32 v141, v141, v13
  v_mul_f32 v142, v142, v13
  v_mul_f32 v143, v143, v13
  v_mul_f32 v144, v144, v13
  s_add_u32 m0, s28, 9216
  s_add_u32 s33, s23, 9216
  buffer_load_dwordx4 v4, s[8:11], s33 offen lds
  v_mul_f32 v145, v145, v13
  v_mul_f32 v146, v146, v13
  v_mul_f32 v147, v147, v13
  v_cvt_pk_bf16_f32 v88, v140, v141
  v_cvt_pk_bf16_f32 v89, v142, v143
  v_cvt_pk_bf16_f32 v90, v144, v145
  v_cvt_pk_bf16_f32 v91, v146, v147
  ds_write_b128 v138, v[88:91] offset:0
  s_add_u32 m0, s28, 10240
  s_add_u32 s33, s23, 10240
  buffer_load_dwordx4 v4, s[8:11], s33 offen lds
  s_waitcnt vmcnt(16)
  ds_read_b128 v[112:115], v6 offset:4352
  ds_read_b128 v[116:119], v7 offset:4352
  ds_read_b128 v[120:123], v8 offset:4352
  ds_read_b128 v[124:127], v9 offset:4352
  s_waitcnt lgkmcnt(3)
  v_cvt_pk_bf16_f32 v112, v112, v113
  v_cvt_pk_bf16_f32 v113, v114, v115
  s_waitcnt lgkmcnt(2)
  v_cvt_pk_bf16_f32 v114, v116, v117
  v_cvt_pk_bf16_f32 v115, v118, v119
  s_add_u32 s33, s22, 8192
  buffer_load_dwordx4 v[48:51], v4, s[8:11], s33 offen
  s_waitcnt lgkmcnt(1)
  v_cvt_pk_bf16_f32 v116, v120, v121
  v_cvt_pk_bf16_f32 v117, v122, v123
  s_waitcnt lgkmcnt(0)
  v_cvt_pk_bf16_f32 v118, v124, v125
  v_cvt_pk_bf16_f32 v119, v126, v127
  s_waitcnt vmcnt(16)
  v_mfma_f32_32x32x16_bf16 v[140:155], v[112:115], v[32:35], 0
  s_add_u32 s33, s22, 9216
  buffer_load_dwordx4 v[52:55], v4, s[8:11], s33 offen
  s_waitcnt vmcnt(16)
  v_mfma_f32_32x32x16_bf16 v[140:155], v[116:119], v[36:39], v[140:155]
  v_add_f32 v13, 0x358637bd, v164
  v_rcp_f32 v13, v13
  s_nop 0
  v_mul_f32 v156, v156, v13
  s_add_u32 s33, s24, 2048
  buffer_load_dwordx4 a[8:11], v4, s[8:11], s33 offen
  v_mul_f32 v157, v157, v13
  v_mul_f32 v158, v158, v13
  v_mul_f32 v159, v159, v13
  v_mul_f32 v160, v160, v13
  v_mul_f32 v161, v161, v13
  v_mul_f32 v162, v162, v13
  v_mul_f32 v163, v163, v13
  v_cvt_pk_bf16_f32 v104, v156, v157
  s_add_u32 s33, s24, 3072
  buffer_load_dwordx4 a[12:15], v4, s[8:11], s33 offen
  v_cvt_pk_bf16_f32 v105, v158, v159
  v_cvt_pk_bf16_f32 v106, v160, v161
  v_cvt_pk_bf16_f32 v107, v162, v163
  ds_write_b128 v138, v[104:107] offset:1024
  s_waitcnt vmcnt(12)
  ds_read_b128 v[80:83], v6 offset:6528
  ds_read_b128 v[84:87], v7 offset:6528
  ds_read_b128 v[88:91], v8 offset:6528
  ds_read_b128 v[92:95], v9 offset:6528
  s_add_u32 s33, s24, 10240
  buffer_load_dwordx4 a[40:43], v4, s[8:11], s33 offen
  s_waitcnt lgkmcnt(0)
  s_barrier
  ds_read_b128 v[188:191], v4 offset:0
  ds_read_b128 v[192:195], v4 offset:1024
  ds_read_b128 v[196:199], v4 offset:8192
  ds_read_b128 v[200:203], v4 offset:9216
  ds_read_b128 v[204:207], v4 offset:16384
  ds_read_b128 v[208:211], v4 offset:17408
  ds_read_b128 v[212:215], v4 offset:24576
  ds_read_b128 v[216:219], v4 offset:25600
  s_add_u32 s33, s24, 11264
  buffer_load_dwordx4 a[44:47], v4, s[8:11], s33 offen
  v_cvt_pk_bf16_f32 v80, v80, v81
  v_cvt_pk_bf16_f32 v81, v82, v83
  v_cvt_pk_bf16_f32 v82, v84, v85
  v_cvt_pk_bf16_f32 v83, v86, v87
  v_cvt_pk_bf16_f32 v84, v88, v89
  v_cvt_pk_bf16_f32 v85, v90, v91
  v_cvt_pk_bf16_f32 v86, v92, v93
  v_cvt_pk_bf16_f32 v87, v94, v95
  s_add_u32 m0, s28, 11264
  s_add_u32 s33, s23, 11264
  buffer_load_dwordx4 v4, s[8:11], s33 offen lds
  s_waitcnt vmcnt(14)
  v_mfma_f32_32x32x16_bf16 v[156:171], v[80:83], v[40:43], 0
  s_waitcnt vmcnt(13)
  v_mfma_f32_32x32x16_bf16 v[156:171], v[84:87], v[44:47], v[156:171]
  s_add_u32 m0, s28, 12288
  s_add_u32 s33, s23, 12288
  buffer_load_dwordx4 v4, s[8:11], s33 offen lds
  s_waitcnt lgkmcnt(7)
  v_mfma_f32_32x32x16_bf16 v[172:187], a[0:3], v[188:191], 0
  s_waitcnt lgkmcnt(6)
  v_mfma_f32_32x32x16_bf16 v[172:187], a[4:7], v[192:195], v[172:187]
  s_add_u32 s33, s22, 10240
  buffer_load_dwordx4 v[56:59], v4, s[8:11], s33 offen
  s_waitcnt lgkmcnt(5)
  v_mfma_f32_32x32x16_bf16 v[172:187], a[32:35], v[196:199], v[172:187]
  s_waitcnt lgkmcnt(4)
  v_mfma_f32_32x32x16_bf16 v[172:187], a[36:39], v[200:203], v[172:187]
  s_add_u32 s33, s22, 11264
  buffer_load_dwordx4 v[60:63], v4, s[8:11], s33 offen
  v_add_f32 v13, 0x358637bd, v148
  v_rcp_f32 v13, v13
  s_nop 0
  v_mul_f32 v140, v140, v13
  v_mul_f32 v141, v141, v13
  v_mul_f32 v142, v142, v13
  v_mul_f32 v143, v143, v13
  v_mul_f32 v144, v144, v13
  s_add_u32 s33, s24, 18432
  buffer_load_dwordx4 a[72:75], v4, s[8:11], s33 offen
  v_mul_f32 v145, v145, v13
  v_mul_f32 v146, v146, v13
  v_mul_f32 v147, v147, v13
  v_cvt_pk_bf16_f32 v120, v140, v141
  v_cvt_pk_bf16_f32 v121, v142, v143
  v_cvt_pk_bf16_f32 v122, v144, v145
  v_cvt_pk_bf16_f32 v123, v146, v147
  ds_write_b128 v138, v[120:123] offset:2048
  s_add_u32 s33, s24, 19456
  buffer_load_dwordx4 a[76:79], v4, s[8:11], s33 offen
  s_waitcnt vmcnt(12)
  ds_read_b128 v[96:99], v6 offset:8704
  ds_read_b128 v[100:103], v7 offset:8704
  ds_read_b128 v[104:107], v8 offset:8704
  ds_read_b128 v[108:111], v9 offset:8704
  s_waitcnt lgkmcnt(3)
  v_cvt_pk_bf16_f32 v96, v96, v97
  v_cvt_pk_bf16_f32 v97, v98, v99
  s_waitcnt lgkmcnt(2)
  v_cvt_pk_bf16_f32 v98, v100, v101
  v_cvt_pk_bf16_f32 v99, v102, v103
  s_add_u32 s33, s24, 26624
  buffer_load_dwordx4 a[104:107], v4, s[8:11], s33 offen
  s_waitcnt lgkmcnt(1)
  v_cvt_pk_bf16_f32 v100, v104, v105
  v_cvt_pk_bf16_f32 v101, v106, v107
  s_waitcnt lgkmcnt(0)
  v_cvt_pk_bf16_f32 v102, v108, v109
  v_cvt_pk_bf16_f32 v103, v110, v111
  s_waitcnt vmcnt(12)
  v_mfma_f32_32x32x16_bf16 v[140:155], v[96:99], v[48:51], 0
  s_add_u32 s33, s24, 27648
  buffer_load_dwordx4 a[108:111], v4, s[8:11], s33 offen
  s_waitcnt vmcnt(12)
  v_mfma_f32_32x32x16_bf16 v[140:155], v[100:103], v[52:55], v[140:155]
  v_mfma_f32_32x32x16_bf16 v[172:187], a[64:67], v[204:207], v[172:187]
  s_add_u32 m0, s28, 13312
  s_add_u32 s33, s23, 13312
  buffer_load_dwordx4 v4, s[8:11], s33 offen lds
  v_mfma_f32_32x32x16_bf16 v[172:187], a[68:71], v[208:211], v[172:187]
  v_mfma_f32_32x32x16_bf16 v[172:187], a[96:99], v[212:215], v[172:187]
  s_add_u32 m0, s28, 14336
  s_add_u32 s33, s23, 14336
  buffer_load_dwordx4 v4, s[8:11], s33 offen lds
  v_mfma_f32_32x32x16_bf16 v[172:187], a[100:103], v[216:219], v[172:187]
  v_add_f32 v13, 0x358637bd, v164
  v_rcp_f32 v13, v13
  s_nop 0
  v_mul_f32 v156, v156, v13
  s_add_u32 s33, s22, 12288
  buffer_load_dwordx4 v[64:67], v4, s[8:11], s33 offen
  v_mul_f32 v157, v157, v13
  v_mul_f32 v158, v158, v13
  v_mul_f32 v159, v159, v13
  v_mul_f32 v160, v160, v13
  v_mul_f32 v161, v161, v13
  v_mul_f32 v162, v162, v13
  v_mul_f32 v163, v163, v13
  v_cvt_pk_bf16_f32 v88, v156, v157
  s_add_u32 s33, s22, 13312
  buffer_load_dwordx4 v[68:71], v4, s[8:11], s33 offen
  v_cvt_pk_bf16_f32 v89, v158, v159
  v_cvt_pk_bf16_f32 v90, v160, v161
  v_cvt_pk_bf16_f32 v91, v162, v163
  ds_write_b128 v138, v[88:91] offset:3072
  s_waitcnt vmcnt(10)
  ds_read_b128 v[112:115], v6 offset:10880
  ds_read_b128 v[116:119], v7 offset:10880
  ds_read_b128 v[120:123], v8 offset:10880
  ds_read_b128 v[124:127], v9 offset:10880
  s_add_u32 s33, s24, 4096
  buffer_load_dwordx4 a[16:19], v4, s[8:11], s33 offen
  s_waitcnt lgkmcnt(0)
  s_barrier
  ds_read_b128 v[188:191], v4 offset:2048
  ds_read_b128 v[192:195], v4 offset:3072
  ds_read_b128 v[196:199], v4 offset:10240
  ds_read_b128 v[200:203], v4 offset:11264
  ds_read_b128 v[204:207], v4 offset:18432
  ds_read_b128 v[208:211], v4 offset:19456
  ds_read_b128 v[212:215], v4 offset:26624
  ds_read_b128 v[216:219], v4 offset:27648
  s_add_u32 s33, s24, 5120
  buffer_load_dwordx4 a[20:23], v4, s[8:11], s33 offen
  v_cvt_pk_bf16_f32 v112, v112, v113
  v_cvt_pk_bf16_f32 v113, v114, v115
  v_cvt_pk_bf16_f32 v114, v116, v117
  v_cvt_pk_bf16_f32 v115, v118, v119
  v_cvt_pk_bf16_f32 v116, v120, v121
  v_cvt_pk_bf16_f32 v117, v122, v123
  v_cvt_pk_bf16_f32 v118, v124, v125
  v_cvt_pk_bf16_f32 v119, v126, v127
  s_add_u32 s33, s24, 12288
  buffer_load_dwordx4 a[48:51], v4, s[8:11], s33 offen
  s_waitcnt vmcnt(12)
  v_mfma_f32_32x32x16_bf16 v[156:171], v[112:115], v[56:59], 0
  s_waitcnt vmcnt(11)
  v_mfma_f32_32x32x16_bf16 v[156:171], v[116:119], v[60:63], v[156:171]
  s_add_u32 s33, s24, 13312
  buffer_load_dwordx4 a[52:55], v4, s[8:11], s33 offen
  s_waitcnt lgkmcnt(7)
  v_mfma_f32_32x32x16_bf16 v[172:187], a[8:11], v[188:191], v[172:187]
  s_waitcnt lgkmcnt(6)
  v_mfma_f32_32x32x16_bf16 v[172:187], a[12:15], v[192:195], v[172:187]
  s_add_u32 m0, s28, 15360
  s_add_u32 s33, s23, 15360
  buffer_load_dwordx4 v4, s[8:11], s33 offen lds
  s_waitcnt lgkmcnt(5)
  v_mfma_f32_32x32x16_bf16 v[172:187], a[40:43], v[196:199], v[172:187]
  s_waitcnt lgkmcnt(4)
  v_mfma_f32_32x32x16_bf16 v[172:187], a[44:47], v[200:203], v[172:187]
  s_add_u32 m0, s28, 16384
  s_add_u32 s33, s23, 16384
  buffer_load_dwordx4 v4, s[8:11], s33 offen lds
  v_add_f32 v13, 0x358637bd, v148
  v_rcp_f32 v13, v13
  s_nop 0
  v_mul_f32 v140, v140, v13
  v_mul_f32 v141, v141, v13
  v_mul_f32 v142, v142, v13
  v_mul_f32 v143, v143, v13
  v_mul_f32 v144, v144, v13
  s_add_u32 s33, s22, 14336
  buffer_load_dwordx4 v[72:75], v4, s[8:11], s33 offen
  v_mul_f32 v145, v145, v13
  v_mul_f32 v146, v146, v13
  v_mul_f32 v147, v147, v13
  v_cvt_pk_bf16_f32 v104, v140, v141
  v_cvt_pk_bf16_f32 v105, v142, v143
  v_cvt_pk_bf16_f32 v106, v144, v145
  v_cvt_pk_bf16_f32 v107, v146, v147
  ds_write_b128 v138, v[104:107] offset:4096
  s_add_u32 s33, s22, 15360
  buffer_load_dwordx4 v[76:79], v4, s[8:11], s33 offen
  s_waitcnt vmcnt(10)
  ds_read_b128 v[80:83], v6 offset:13056
  ds_read_b128 v[84:87], v7 offset:13056
  ds_read_b128 v[88:91], v8 offset:13056
  ds_read_b128 v[92:95], v9 offset:13056
  s_waitcnt lgkmcnt(3)
  v_cvt_pk_bf16_f32 v80, v80, v81
  v_cvt_pk_bf16_f32 v81, v82, v83
  s_waitcnt lgkmcnt(2)
  v_cvt_pk_bf16_f32 v82, v84, v85
  v_cvt_pk_bf16_f32 v83, v86, v87
  s_add_u32 s33, s24, 20480
  buffer_load_dwordx4 a[80:83], v4, s[8:11], s33 offen
  s_waitcnt lgkmcnt(1)
  v_cvt_pk_bf16_f32 v84, v88, v89
  v_cvt_pk_bf16_f32 v85, v90, v91
  s_waitcnt lgkmcnt(0)
  v_cvt_pk_bf16_f32 v86, v92, v93
  v_cvt_pk_bf16_f32 v87, v94, v95
  s_waitcnt vmcnt(10)
  v_mfma_f32_32x32x16_bf16 v[140:155], v[80:83], v[64:67], 0
  s_add_u32 s33, s24, 21504
  buffer_load_dwordx4 a[84:87], v4, s[8:11], s33 offen
  s_waitcnt vmcnt(10)
  v_mfma_f32_32x32x16_bf16 v[140:155], v[84:87], v[68:71], v[140:155]
  v_mfma_f32_32x32x16_bf16 v[172:187], a[72:75], v[204:207], v[172:187]
  s_add_u32 s33, s24, 28672
  buffer_load_dwordx4 a[112:115], v4, s[8:11], s33 offen
  v_mfma_f32_32x32x16_bf16 v[172:187], a[76:79], v[208:211], v[172:187]
  v_mfma_f32_32x32x16_bf16 v[172:187], a[104:107], v[212:215], v[172:187]
  s_add_u32 s33, s24, 29696
  buffer_load_dwordx4 a[116:119], v4, s[8:11], s33 offen
  v_mfma_f32_32x32x16_bf16 v[172:187], a[108:111], v[216:219], v[172:187]
  v_add_f32 v13, 0x358637bd, v164
  v_rcp_f32 v13, v13
  s_nop 0
  v_mul_f32 v156, v156, v13
  s_add_u32 m0, s34, 0
  s_add_u32 s33, s25, 0
  buffer_load_dwordx4 v10, s[8:11], s33 offen lds
  v_mul_f32 v157, v157, v13
  v_mul_f32 v158, v158, v13
  v_mul_f32 v159, v159, v13
  v_mul_f32 v160, v160, v13
  v_mul_f32 v161, v161, v13
  v_mul_f32 v162, v162, v13
  v_mul_f32 v163, v163, v13
  v_cvt_pk_bf16_f32 v120, v156, v157
  s_add_u32 m0, s34, 1024
  s_add_u32 s33, s25, 65536
  buffer_load_dwordx4 v10, s[8:11], s33 offen lds
  v_cvt_pk_bf16_f32 v121, v158, v159
  v_cvt_pk_bf16_f32 v122, v160, v161
  v_cvt_pk_bf16_f32 v123, v162, v163
  ds_write_b128 v138, v[120:123] offset:5120
  s_waitcnt vmcnt(8)
  ds_read_b128 v[96:99], v6 offset:15232
  ds_read_b128 v[100:103], v7 offset:15232
  ds_read_b128 v[104:107], v8 offset:15232
  ds_read_b128 v[108:111], v9 offset:15232
  buffer_load_dword v136, v11, s[8:11], s26 offen
  s_waitcnt lgkmcnt(0)
  s_barrier
  ds_read_b128 v[188:191], v4 offset:4096
  ds_read_b128 v[192:195], v4 offset:5120
  ds_read_b128 v[196:199], v4 offset:12288
  ds_read_b128 v[200:203], v4 offset:13312
  ds_read_b128 v[204:207], v4 offset:20480
  ds_read_b128 v[208:211], v4 offset:21504
  ds_read_b128 v[212:215], v4 offset:28672
  ds_read_b128 v[216:219], v4 offset:29696
  s_add_u32 s33, s24, 6144
  buffer_load_dwordx4 a[24:27], v4, s[8:11], s33 offen
  v_cvt_pk_bf16_f32 v96, v96, v97
  v_cvt_pk_bf16_f32 v97, v98, v99
  v_cvt_pk_bf16_f32 v98, v100, v101
  v_cvt_pk_bf16_f32 v99, v102, v103
  v_cvt_pk_bf16_f32 v100, v104, v105
  v_cvt_pk_bf16_f32 v101, v106, v107
  v_cvt_pk_bf16_f32 v102, v108, v109
  v_cvt_pk_bf16_f32 v103, v110, v111
  s_add_u32 s33, s24, 7168
  buffer_load_dwordx4 a[28:31], v4, s[8:11], s33 offen
  s_waitcnt vmcnt(10)
  v_mfma_f32_32x32x16_bf16 v[156:171], v[96:99], v[72:75], 0
  s_waitcnt vmcnt(9)
  v_mfma_f32_32x32x16_bf16 v[156:171], v[100:103], v[76:79], v[156:171]
  s_add_u32 s33, s24, 14336
  buffer_load_dwordx4 a[56:59], v4, s[8:11], s33 offen
  s_waitcnt lgkmcnt(7)
  v_mfma_f32_32x32x16_bf16 v[172:187], a[16:19], v[188:191], v[172:187]
  s_waitcnt lgkmcnt(6)
  v_mfma_f32_32x32x16_bf16 v[172:187], a[20:23], v[192:195], v[172:187]
  s_add_u32 s33, s24, 15360
  buffer_load_dwordx4 a[60:63], v4, s[8:11], s33 offen
  s_waitcnt lgkmcnt(5)
  v_mfma_f32_32x32x16_bf16 v[172:187], a[48:51], v[196:199], v[172:187]
  s_waitcnt lgkmcnt(4)
  v_mfma_f32_32x32x16_bf16 v[172:187], a[52:55], v[200:203], v[172:187]
  s_add_u32 s33, s24, 22528
  buffer_load_dwordx4 a[88:91], v4, s[8:11], s33 offen
  v_add_f32 v13, 0x358637bd, v148
  v_rcp_f32 v13, v13
  s_nop 0
  v_mul_f32 v140, v140, v13
  v_mul_f32 v141, v141, v13
  v_mul_f32 v142, v142, v13
  v_mul_f32 v143, v143, v13
  v_mul_f32 v144, v144, v13
  s_add_u32 s33, s24, 23552
  buffer_load_dwordx4 a[92:95], v4, s[8:11], s33 offen
  v_mul_f32 v145, v145, v13
  v_mul_f32 v146, v146, v13
  v_mul_f32 v147, v147, v13
  v_cvt_pk_bf16_f32 v88, v140, v141
  v_cvt_pk_bf16_f32 v89, v142, v143
  v_cvt_pk_bf16_f32 v90, v144, v145
  v_cvt_pk_bf16_f32 v91, v146, v147
  ds_write_b128 v138, v[88:91] offset:6144
  s_add_u32 s33, s24, 30720
  buffer_load_dwordx4 a[120:123], v4, s[8:11], s33 offen
  s_waitcnt vmcnt(13) lgkmcnt(4)
  v_mfma_f32_32x32x16_bf16 v[172:187], a[80:83], v[204:207], v[172:187]
  s_waitcnt vmcnt(12) lgkmcnt(3)
  v_mfma_f32_32x32x16_bf16 v[172:187], a[84:87], v[208:211], v[172:187]
  s_add_u32 s33, s24, 31744
  buffer_load_dwordx4 a[124:127], v4, s[8:11], s33 offen
  s_waitcnt vmcnt(12) lgkmcnt(2)
  v_mfma_f32_32x32x16_bf16 v[172:187], a[112:115], v[212:215], v[172:187]
  s_waitcnt vmcnt(11) lgkmcnt(1)
  v_mfma_f32_32x32x16_bf16 v[172:187], a[116:119], v[216:219], v[172:187]
  v_add_f32 v13, 0x358637bd, v164
  v_rcp_f32 v13, v13
  s_nop 0
  v_mul_f32 v156, v156, v13
  v_mul_f32 v157, v157, v13
  v_mul_f32 v158, v158, v13
  v_mul_f32 v159, v159, v13
  v_mul_f32 v160, v160, v13
  v_mul_f32 v161, v161, v13
  v_mul_f32 v162, v162, v13
  v_mul_f32 v163, v163, v13
  v_cvt_pk_bf16_f32 v104, v156, v157
  v_cvt_pk_bf16_f32 v105, v158, v159
  v_cvt_pk_bf16_f32 v106, v160, v161
  v_cvt_pk_bf16_f32 v107, v162, v163
  ds_write_b128 v138, v[104:107] offset:7168
  s_waitcnt lgkmcnt(0)
  s_barrier
  ds_read_b128 v[188:191], v4 offset:6144
  ds_read_b128 v[192:195], v4 offset:7168
  ds_read_b128 v[196:199], v4 offset:14336
  ds_read_b128 v[200:203], v4 offset:15360
  ds_read_b128 v[204:207], v4 offset:22528
  ds_read_b128 v[208:211], v4 offset:23552
  ds_read_b128 v[212:215], v4 offset:30720
  ds_read_b128 v[216:219], v4 offset:31744
  s_waitcnt vmcnt(9)
  ds_read_b64_tr_b16 v[128:129], v137 offset:0
  ds_read_b64_tr_b16 v[130:131], v137 offset:512
  ds_read_b64_tr_b16 v[132:133], v137 offset:1024
  ds_read_b64_tr_b16 v[134:135], v137 offset:1536
  s_waitcnt vmcnt(8)
  v_sub_f32 v14, 1.0, v136
  v_cvt_pk_bf16_f32 v14, v14, v14
  v_lshlrev_b32 v14, 16, v14
  s_waitcnt vmcnt(7) lgkmcnt(11)
  v_mfma_f32_32x32x16_bf16 v[172:187], a[24:27], v[188:191], v[172:187]
  s_waitcnt lgkmcnt(3)
  v_lshlrev_b32 v80, 16, v128
  v_and_b32 v81, 0xffff0000, v128
  v_mul_f32 v80, v14, v80
  v_mul_f32 v81, v14, v81
  s_waitcnt vmcnt(6)
  v_mfma_f32_32x32x16_bf16 v[172:187], a[28:31], v[192:195], v[172:187]
  v_lshlrev_b32 v82, 16, v129
  v_and_b32 v83, 0xffff0000, v129
  v_mul_f32 v82, v14, v82
  v_mul_f32 v83, v14, v83
  s_waitcnt vmcnt(5)
  v_mfma_f32_32x32x16_bf16 v[172:187], a[56:59], v[196:199], v[172:187]
  s_waitcnt lgkmcnt(2)
  v_lshlrev_b32 v84, 16, v130
  v_and_b32 v85, 0xffff0000, v130
  v_mul_f32 v84, v14, v84
  v_mul_f32 v85, v14, v85
  s_waitcnt vmcnt(4)
  v_mfma_f32_32x32x16_bf16 v[172:187], a[60:63], v[200:203], v[172:187]
  v_lshlrev_b32 v86, 16, v131
  v_and_b32 v87, 0xffff0000, v131
  v_mul_f32 v86, v14, v86
  v_mul_f32 v87, v14, v87
  s_waitcnt vmcnt(3)
  v_mfma_f32_32x32x16_bf16 v[172:187], a[88:91], v[204:207], v[172:187]
  s_waitcnt lgkmcnt(1)
  v_lshlrev_b32 v88, 16, v132
  v_and_b32 v89, 0xffff0000, v132
  v_mul_f32 v88, v14, v88
  v_mul_f32 v89, v14, v89
  s_waitcnt vmcnt(2)
  v_mfma_f32_32x32x16_bf16 v[172:187], a[92:95], v[208:211], v[172:187]
  v_lshlrev_b32 v90, 16, v133
  v_and_b32 v91, 0xffff0000, v133
  v_mul_f32 v90, v14, v90
  v_mul_f32 v91, v14, v91
  s_waitcnt vmcnt(1)
  v_mfma_f32_32x32x16_bf16 v[172:187], a[120:123], v[212:215], v[172:187]
  s_waitcnt lgkmcnt(0)
  v_lshlrev_b32 v92, 16, v134
  v_and_b32 v93, 0xffff0000, v134
  v_mul_f32 v92, v14, v92
  v_mul_f32 v93, v14, v93
  s_waitcnt vmcnt(0)
  v_mfma_f32_32x32x16_bf16 v[172:187], a[124:127], v[216:219], v[172:187]
  v_lshlrev_b32 v94, 16, v135
  v_and_b32 v95, 0xffff0000, v135
  v_mul_f32 v94, v14, v94
  v_mul_f32 v95, v14, v95
  s_nop 7
  v_fmac_f32 v80, v136, v172
  v_fmac_f32 v81, v136, v173
  v_fmac_f32 v82, v136, v174
  v_fmac_f32 v83, v136, v175
  v_fmac_f32 v84, v136, v176
  v_fmac_f32 v85, v136, v177
  v_fmac_f32 v86, v136, v178
  v_fmac_f32 v87, v136, v179
  v_fmac_f32 v88, v136, v180
  v_fmac_f32 v89, v136, v181
  v_fmac_f32 v90, v136, v182
  v_fmac_f32 v91, v136, v183
  v_fmac_f32 v92, v136, v184
  v_fmac_f32 v93, v136, v185
  v_fmac_f32 v94, v136, v186
  v_fmac_f32 v95, v136, v187
  v_cvt_pk_bf16_f32 v96, v80, v81
  v_cvt_pk_bf16_f32 v97, v82, v83
  v_cvt_pk_bf16_f32 v98, v84, v85
  v_cvt_pk_bf16_f32 v99, v86, v87
  v_cvt_pk_bf16_f32 v100, v88, v89
  v_cvt_pk_bf16_f32 v101, v90, v91
  v_cvt_pk_bf16_f32 v102, v92, v93
  v_cvt_pk_bf16_f32 v103, v94, v95
  v_permlane32_swap_b32 v96, v98
  v_permlane32_swap_b32 v97, v99
  buffer_store_dwordx4 v[96:99], v12, s[12:15], s27 offen offset:0
  v_permlane32_swap_b32 v100, v102
  v_permlane32_swap_b32 v101, v103
  buffer_store_dwordx4 v[100:103], v12, s[12:15], s27 offen offset:32
L_fin_kernel_end:
  s_endpgm
L_code_end:

.section .rodata,"a"
.p2align 6
.amdhsa_kernel fin_kernel
  .amdhsa_next_free_vgpr 384
  .amdhsa_next_free_sgpr 40
  .amdhsa_accum_offset 256
  .amdhsa_group_segment_fixed_size 0
  .amdhsa_kernarg_size 120
  .amdhsa_user_sgpr_count 2
  .amdhsa_user_sgpr_kernarg_segment_ptr 1
  .amdhsa_system_sgpr_workgroup_id_x 1
.end_amdhsa_kernel
.text
```
